```python
import torch

def _softmax(x, axis=-1):
    return torch.softmax(x, dim=axis)
def _gelu(x):
    return torch.nn.functional.gelu(x, approximate="tanh")
def _silu(x):
    return torch.nn.functional.silu(x)
def _sigmoid(x):
    return torch.sigmoid(x)
def _layernorm(x, axis=-1, eps=1e-5):
    m = x.mean(dim=axis, keepdim=True)
    v = x.var(dim=axis, keepdim=True, unbiased=False)
    return (x - m) / torch.sqrt(v + eps)
def _scatter_add(tgt, idx, src, axis=0):
    return tgt.clone().index_add_(axis, idx, src)
def _segment_sum(src, seg, n):
    out = torch.zeros((n,) + src.shape[1:], dtype=src.dtype)
    return out.index_add_(0, seg, src)
def _pad(x, pw):
    flat = tuple(v for pair in reversed(pw) for v in pair)
    return torch.nn.functional.pad(x, flat)

kernel_name = 'concat_heads__linear_attn_block__ssm_conv_s4d__prompt'

def setup_inputs():

    _w = (lambda a: (lambda t: t.to(torch.bfloat16) if t.is_floating_point() else t)(torch.as_tensor(a)))
    def _A_setup():
        B, S, D = 1, 2048, 512
        return {
            "x": _w((lambda *s: torch.randn(*s, dtype=torch.bfloat16) * 0.05)(B, S, D)),
            "wqkv": _w((lambda *s: torch.randn(*s, dtype=torch.bfloat16) * 0.4)(D, 3 * D)),
            "wo": _w((lambda *s: torch.randn(*s, dtype=torch.bfloat16) * 0.05)(D, D)),
        }
    _A_in = _A_setup()

    def _B_setup():
        Bsz, L, D, N = 1, 2048, 512, 128
        return {
            "u": _w((lambda *s: torch.randn(*s, dtype=torch.bfloat16) * 0.05)(Bsz, L, D)),
            "log_A_real": _w((lambda *s: torch.randn(*s, dtype=torch.bfloat16) * 6.4)(D, N) * 0.5),
            "A_imag": _w((lambda *s: torch.randn(*s, dtype=torch.bfloat16) * 0.05)(D, N) * 3.14),
            "C_real": _w((lambda *s: torch.randn(*s, dtype=torch.bfloat16) * 0.1)(D, N) / N ** 0.5),
            "C_imag": _w((lambda *s: torch.randn(*s, dtype=torch.bfloat16) * 0.1)(D, N) / N ** 0.5),
            "log_dt": _w((lambda *s: torch.randn(*s, dtype=torch.bfloat16) * 0.05)(D) * 0.5 - 4.0),
            "D_skip": _w((lambda *s: torch.randn(*s, dtype=torch.bfloat16) * 0.05)(D)),
        }
    _B_in = _B_setup()

    return {
        "A_x": _A_in["x"],
        "A_wqkv": _A_in["wqkv"],
        "A_wo": _A_in["wo"],
        "B_u": _B_in["u"],
        "B_log_A_real": _B_in["log_A_real"],
        "B_A_imag": _B_in["A_imag"],
        "B_C_real": _B_in["C_real"],
        "B_C_imag": _B_in["C_imag"],
        "B_log_dt": _B_in["log_dt"],
        "B_D_skip": _B_in["D_skip"],
    }

def reference(A_x, A_wqkv, A_wo, B_u, B_log_A_real, B_A_imag, B_C_real, B_C_imag, B_log_dt, B_D_skip):
    def _A_ref(x, wqkv, wo):
        B, S, D = x.shape
        H = 32; Dh = D // H
        qkv = (lambda x, *d: x.permute(*d))((x @ wqkv).reshape(B, S, 3, H, Dh), 2, 0, 3, 1, 4)
        q, k, v = qkv[0], qkv[1], qkv[2]
        phi = lambda t: torch.where(t > 0, t + 1, torch.exp(t)) + 1e-6
        pq, pk = phi(q), phi(k)
        kv = torch.einsum("bhsd,bhse->bhde", pk, v)
        z = torch.einsum("bhsd->bhd", pk)
        num = torch.einsum("bhqd,bhde->bhqe", pq, kv)
        den = torch.einsum("bhqd,bhd->bhq", pq, z)[..., None] + 1e-6
        o = num / den
        return (lambda x, *d: x.permute(*d))(o, 0, 2, 1, 3).reshape(B, S, D) @ wo

    def _B_ref(u, log_A_real, A_imag, C_real, C_imag, log_dt, D_skip):
        L = u.shape[1]
        dt = torch.exp(log_dt)
        A = -torch.exp(log_A_real) + 1j * A_imag
        C = (C_real + 1j * C_imag) * dt[:, None]
        pos = (lambda x, dt: x.to(dt))(torch.arange(L), log_dt.dtype)
        P = torch.exp((A * dt[:, None])[:, :, None] * pos[None, None, :])
        K = 2.0 * torch.einsum("dn,dnl->dl", C, P).real
        L2 = 2 * L
        u_t = (lambda x, *d: x.permute(*d))(u, 0, 2, 1)
        Kf = (lambda x, *a, **k: torch.fft.rfft(x.float(), *a, **k))(K, L2)
        Uf = (lambda x, *a, **k: torch.fft.rfft(x.float(), *a, **k))(u_t, L2)
        y = (lambda x, *a, **k: torch.fft.irfft(x, *a, **k).to(torch.bfloat16))(Uf * Kf[None, :, :], L2)[:, :, :L]
        y = (lambda x, *d: x.permute(*d))(y, 0, 2, 1)
        return y + u * D_skip[None, None, :]

    a = _A_ref(A_x, A_wqkv, A_wo)
    b = _B_ref(B_u, B_log_A_real, B_A_imag, B_C_real, B_C_imag, B_log_dt, B_D_skip)
    return torch.concatenate([a, b], axis=-1)
```

```asm
; @launch grid=(512,1,1) block=(256,1,1) lds=81920
.amdgcn_target "amdgcn-amd-amdhsa--gfx950"
.text
.globl concat_heads__linear_attn_block__ssm_conv_s4d__prompt_kernel
.p2align 8
.type concat_heads__linear_attn_block__ssm_conv_s4d__prompt_kernel,@function
concat_heads__linear_attn_block__ssm_conv_s4d__prompt_kernel:
  s_load_dwordx16 s[16:31], s[0:1], 0
  s_load_dwordx8 s[32:39], s[0:1], 64
  s_load_dwordx2 s[40:41], s[0:1], 96
  s_getpc_b64 s[4:5]
  v_lshlrev_b32 v1, 7, v0
  v_min_u32 v1, L_code_end - concat_heads__linear_attn_block__ssm_conv_s4d__prompt_kernel - 160, v1
  s_cmp_ge_u32 s2, 64
  s_cbranch_scc1 L_nopf
  global_load_dword v255, v1, s[4:5]
  global_load_dword v255, v1, s[4:5] offset:32
  global_load_dword v255, v1, s[4:5] offset:64
  global_load_dword v255, v1, s[4:5] offset:96
L_nopf:
  s_cmp_ge_u32 s2, 512
  s_cbranch_scc1 L_exit
  s_cmp_ge_u32 s2, 256
  s_cbranch_scc1 L_roleB
  s_setprio 2
  s_and_b32 s56, s2, 7
  s_lshr_b32 s57, s2, 3
  s_lshr_b32 s53, s56, 1
  s_lshl_b32 s53, s53, 3
  s_and_b32 s55, s57, 7
  s_add_u32 s53, s53, s55
  s_and_b32 s54, s56, 1
  s_lshl_b32 s54, s54, 2
  s_lshr_b32 s63, s57, 3
  s_add_u32 s54, s54, s63
  s_lshl_b32 s63, s63, 1
  s_and_b32 s55, s55, 1
  s_and_b32 s14, s56, 6
  s_add_u32 s55, s55, s14
  s_lshl_b32 s63, s63, 1
  s_add_u32 s55, s55, s63
  s_and_b32 s55, s55, 7
  v_lshrrev_b32 v1, 6, v0
  v_and_b32 v2, 63, v0
  v_readfirstlane_b32 s52, v1
  v_lshrrev_b32 v3, 3, v2
  v_and_b32 v4, 7, v2
  v_lshrrev_b32 v5, 4, v2
  v_xor_b32 v6, v5, v4
  v_xor_b32 v7, 4, v6
  s_lshl_b32 s56, s53, 16
  s_lshl_b32 s57, s52, 14
  s_add_u32 s56, s56, s57
  v_lshlrev_b32 v8, 10, v3
  v_add_u32 v8, s56, v8
  v_lshl_add_u32 v6, v6, 4, v8
  v_lshl_add_u32 v7, v7, 4, v8
  v_add_u32 v7, 0x2000, v7
  v_and_b32 v5, 1, v5
  v_lshlrev_b32 v5, 2, v5
  v_xor_b32 v5, v5, v4
  s_lshl_b32 s56, s52, 3
  v_add_u32 v8, s56, v3
  v_mul_u32_u24 v8, 3072, v8
  v_lshl_add_u32 v8, v5, 4, v8
  s_lshl_b32 s56, s54, 7
  v_add_u32 v8, s56, v8
  s_mul_i32 s66, s52, 3072
  s_lshl_b32 s65, s52, 11
  s_add_u32 s65, s65, 49152
  s_waitcnt lgkmcnt(0)
  s_mov_b32 s72, s16
  s_and_b32 s73, s17, 0xffff
  s_mov_b32 s74, 2097152
  s_mov_b32 s75, 0x20000
  s_mov_b32 s48, s18
  s_and_b32 s49, s19, 0xffff
  s_mov_b32 s50, 1572864
  s_mov_b32 s51, 0x20000
  s_cmp_lg_u32 s53, 0
  s_cbranch_scc1 LA_nozero
  s_lshl_b32 s56, s54, 13
  s_add_u32 s56, s56, 2162688
  v_lshl_add_u32 v9, v0, 3, s56
  v_add_u32 v10, 0x1000, v9
  s_lshl_b32 s56, s52, 3
  s_add_u32 s56, s56, s54
  s_mul_i32 s56, s56, 4352
  s_add_u32 s56, s56, 2293760
  v_lshl_add_u32 v11, v2, 2, s56
  v_mov_b32 v12, 0
  v_mov_b32 v13, 0
  v_mov_b32 v14, 0
  v_mov_b32 v15, 0
  global_store_dword v11, v12, s[40:41] sc1
  global_atomic_swap_x2 v9, v[12:13], s[40:41] offset:0
  global_atomic_swap_x2 v9, v[12:13], s[40:41] offset:2048
  global_atomic_swap_x2 v10, v[12:13], s[40:41] offset:0
  global_atomic_swap_x2 v10, v[12:13], s[40:41] offset:2048
LA_nozero:
  s_add_u32 s56, s55, 0
  s_and_b32 s56, s56, 7
  s_lshl_b32 s56, s56, 7
  s_add_u32 s57, s65, 0
  s_mov_b32 m0, s57
  s_nop 0
  buffer_load_dwordx4 v6, s[72:75], s56 offen lds
  s_add_u32 m0, s57, 1024
  s_nop 0
  buffer_load_dwordx4 v7, s[72:75], s56 offen lds
  s_add_u32 s56, s55, 0
  s_and_b32 s56, s56, 7
  s_mul_i32 s56, s56, 196608
  s_add_u32 s56, s56, 0
  s_add_u32 s57, s66, 0
  s_mov_b32 m0, s57
  s_nop 0
  buffer_load_dwordx4 v8, s[48:51], s56 offen lds
  buffer_load_dwordx4 v8, s[48:51], s56 offen offset:1024 lds
  buffer_load_dwordx4 v8, s[48:51], s56 offen offset:2048 lds
  s_add_u32 s56, s55, 0
  s_and_b32 s56, s56, 7
  s_mul_i32 s56, s56, 196608
  s_add_u32 s56, s56, 98304
  s_add_u32 s57, s66, 12288
  s_mov_b32 m0, s57
  s_nop 0
  buffer_load_dwordx4 v8, s[48:51], s56 offen lds
  buffer_load_dwordx4 v8, s[48:51], s56 offen offset:1024 lds
  buffer_load_dwordx4 v8, s[48:51], s56 offen offset:2048 lds
  s_add_u32 s56, s55, 1
  s_and_b32 s56, s56, 7
  s_lshl_b32 s56, s56, 7
  s_add_u32 s57, s65, 8192
  s_mov_b32 m0, s57
  s_nop 0
  buffer_load_dwordx4 v6, s[72:75], s56 offen lds
  s_add_u32 m0, s57, 1024
  s_nop 0
  buffer_load_dwordx4 v7, s[72:75], s56 offen lds
  s_add_u32 s56, s55, 1
  s_and_b32 s56, s56, 7
  s_mul_i32 s56, s56, 196608
  s_add_u32 s56, s56, 0
  s_add_u32 s57, s66, 24576
  s_mov_b32 m0, s57
  s_nop 0
  buffer_load_dwordx4 v8, s[48:51], s56 offen lds
  buffer_load_dwordx4 v8, s[48:51], s56 offen offset:1024 lds
  buffer_load_dwordx4 v8, s[48:51], s56 offen offset:2048 lds
  s_add_u32 s56, s55, 1
  s_and_b32 s56, s56, 7
  s_mul_i32 s56, s56, 196608
  s_add_u32 s56, s56, 98304
  s_add_u32 s57, s66, 36864
  s_mov_b32 m0, s57
  s_nop 0
  buffer_load_dwordx4 v8, s[48:51], s56 offen lds
  buffer_load_dwordx4 v8, s[48:51], s56 offen offset:1024 lds
  buffer_load_dwordx4 v8, s[48:51], s56 offen offset:2048 lds
  s_add_u32 s56, s55, 2
  s_and_b32 s56, s56, 7
  s_lshl_b32 s56, s56, 7
  s_add_u32 s57, s65, 16384
  s_mov_b32 m0, s57
  s_nop 0
  buffer_load_dwordx4 v6, s[72:75], s56 offen lds
  s_add_u32 m0, s57, 1024
  s_nop 0
  buffer_load_dwordx4 v7, s[72:75], s56 offen lds
  s_mov_b32 s68, s20
  s_and_b32 s69, s21, 0xffff
  s_mov_b32 s70, 524288
  s_mov_b32 s71, 0x20000
  s_and_b32 s56, s2, 7
  s_lshr_b32 s57, s2, 3
  s_and_b32 s67, s57, 7
  s_lshl_b32 s46, s56, 3
  s_add_u32 s46, s46, s67
  s_lshr_b32 s47, s57, 3
  s_add_u32 s67, s67, s56
  s_and_b32 s67, s67, 3
  s_lshl_b32 s67, s67, 2
  v_lshrrev_b32 v3, 3, v2
  v_and_b32 v4, 7, v2
  v_bfe_u32 v5, v2, 4, 1
  v_lshlrev_b32 v5, 2, v5
  v_xor_b32 v4, v4, v5
  v_lshlrev_b32 v9, 10, v3
  v_lshl_add_u32 v9, v4, 4, v9
  s_lshl_b32 s56, s47, 8
  s_lshl_b32 s57, s52, 17
  s_add_u32 s56, s56, s57
  v_add_u32 v9, s56, v9
  s_lshr_b32 s12, s52, 1
  s_lshl_b32 s12, s12, 7
  s_xor_b32 s13, s12, 128
  s_and_b32 s56, s52, 1
  s_lshl_b32 s56, s56, 12
  s_add_u32 s56, s56, 49152
  v_and_b32 v3, 31, v2
  v_lshrrev_b32 v4, 5, v2
  v_bfe_u32 v5, v2, 1, 3
  v_xor_b32 v10, v5, v4
  v_lshlrev_b32 v3, 7, v3
  v_lshl_add_u32 v10, v10, 4, v3
  v_add_u32 v10, s56, v10
  v_bfe_u32 v5, v2, 2, 2
  v_lshlrev_b32 v12, 7, v5
  v_mul_u32_u24 v3, 3072, v4
  v_add_u32 v12, v12, v3
  v_bfe_u32 v5, v2, 3, 1
  s_lshr_b32 s56, s52, 1
  v_xor_b32 v5, s56, v5
  v_lshl_add_u32 v12, v5, 6, v12
  v_bfe_u32 v5, v2, 4, 1
  v_lshl_add_u32 v12, v5, 5, v12
  v_and_b32 v5, 3, v2
  v_lshl_add_u32 v12, v5, 3, v12
  v_mov_b32 v3, 0x358637bd
  s_lshl_b32 s56, s54, 2
  v_mov_b32 v1, s56
  v_and_b32 v4, 7, v2
  v_lshlrev_b32 v4, 2, v4
  v_mov_b32 v16, v3
  v_mov_b32 v32, v3
  v_mov_b32 v48, 0
  v_mov_b32 v17, v3
  v_mov_b32 v33, v3
  v_mov_b32 v49, 0
  v_mov_b32 v18, v3
  v_mov_b32 v34, v3
  v_mov_b32 v50, 0
  v_mov_b32 v19, v3
  v_mov_b32 v35, v3
  v_mov_b32 v51, 0
  v_mov_b32 v20, v3
  v_mov_b32 v36, v3
  v_mov_b32 v52, 0
  v_mov_b32 v21, v3
  v_mov_b32 v37, v3
  v_mov_b32 v53, 0
  v_mov_b32 v22, v3
  v_mov_b32 v38, v3
  v_mov_b32 v54, 0
  v_mov_b32 v23, v3
  v_mov_b32 v39, v3
  v_mov_b32 v55, 0
  v_mov_b32 v24, v3
  v_mov_b32 v40, v3
  v_mov_b32 v56, 0
  v_mov_b32 v25, v3
  v_mov_b32 v41, v3
  v_mov_b32 v57, 0
  v_mov_b32 v26, v3
  v_mov_b32 v42, v3
  v_mov_b32 v58, 0
  v_mov_b32 v27, v3
  v_mov_b32 v43, v3
  v_mov_b32 v59, 0
  v_mov_b32 v28, v3
  v_mov_b32 v44, v3
  v_mov_b32 v60, 0
  v_mov_b32 v29, v3
  v_mov_b32 v45, v3
  v_mov_b32 v61, 0
  v_mov_b32 v30, v3
  v_mov_b32 v46, v3
  v_mov_b32 v62, 0
  v_mov_b32 v31, v3
  v_mov_b32 v47, v3
  v_mov_b32 v63, 0
  s_mov_b32 s42, 0x3fb8aa3b
  s_mov_b32 s43, 0x358637bd
  v_and_b32 v100, 16, v2
  v_cmp_ne_u32 s[14:15], 0, v100
  s_lshl_b32 s56, s52, 11
  s_add_u32 s56, s56, 73728
  v_and_b32 v101, 15, v2
  v_lshlrev_b32 v100, 6, v100
  v_lshl_add_u32 v100, v101, 4, v100
  v_lshrrev_b32 v101, 5, v2
  v_lshl_add_u32 v100, v101, 8, v100
  v_add_u32 v240, s56, v100
  v_lshlrev_b32 v100, 2, v2
  s_lshl_b32 s56, s54, 13
  s_lshr_b32 s57, s52, 1
  s_lshl_b32 s57, s57, 12
  s_add_u32 s57, s57, s56
  s_add_u32 s57, s57, 2164736
  v_add_u32 v241, s57, v100
  v_lshlrev_b32 v100, 2, v0
  v_add_u32 v242, 73728, v100
  s_add_u32 s56, s56, 2166784
  v_add_u32 v243, s56, v100
  s_lshl_b32 s56, s53, 1
  s_and_b32 s57, s52, 1
  s_add_u32 s56, s56, s57
  s_lshl_b32 s56, s56, 15
  s_lshl_b32 s57, s54, 12
  s_add_u32 s56, s56, s57
  s_lshr_b32 s57, s52, 1
  s_lshl_b32 s57, s57, 11
  s_add_u32 s56, s56, s57
  s_add_u32 s56, s56, 65536
  v_lshl_add_u32 v248, v2, 4, s56
  s_and_b32 s63, s2, 7
  s_mul_i32 s57, s63, 4352
  s_add_u32 s57, s57, 2293888
  v_mov_b32 v249, s57
  s_lshl_b32 s63, s63, 2
  s_add_u32 s63, s63, 2293760
  v_mul_u32_u24 v250, 4352, v2
  v_add_u32 v250, s63, v250
  v_mov_b32 v3, 0xb5c1a2a0
  v_mov_b32 v208, 0x3f803f80
  v_mov_b32 v209, 0x3f803f80
  v_mov_b32 v210, 0x3f803f80
  v_mov_b32 v211, 0x3f803f80
  v_mov_b32 v212, 1
  v_lshrrev_b32 v96, 5, v2
  v_bfe_u32 v97, v2, 2, 2
  v_lshl_add_u32 v97, v96, 2, v97
  v_lshlrev_b32 v98, 7, v97
  v_bfe_u32 v97, v2, 3, 1
  v_lshl_add_u32 v98, v97, 6, v98
  v_bfe_u32 v97, v2, 4, 1
  v_lshl_add_u32 v98, v97, 5, v98
  v_and_b32 v97, 3, v2
  v_lshl_add_u32 v98, v97, 3, v98
  s_and_b32 s57, s52, 1
  s_lshl_b32 s57, s57, 6
  v_xor_b32 v98, s57, v98
  v_add_u32 v244, s66, v98
  v_xor_b32 v245, 64, v244
  v_add_u32 v246, s65, v98
  v_xor_b32 v247, 64, v246
  s_mov_b32 s58, 0
  s_mov_b32 s59, 0
  s_mov_b32 s60, 0
  v_mov_b32 v13, v10
  v_mov_b32 v15, v12
  v_mov_b32 v5, 1
  s_waitcnt vmcnt(13)
  s_barrier
  s_cmp_lg_u32 s53, 0
  s_cbranch_scc1 LA_noflag
  s_cmp_lg_u32 s52, 0
  s_cbranch_scc1 LA_noflag
  s_mov_b64 exec, 1
  global_store_dword v1, v5, s[38:39] sc1
  s_mov_b64 exec, -1
LA_noflag:
  ds_read_b128 v[64:67], v13
  ds_read_b64_tr_b16 v[72:73], v15 offset:1024
  ds_read_b64_tr_b16 v[74:75], v15 offset:1536
  ds_read_b64_tr_b16 v[76:77], v15 offset:2048
  ds_read_b64_tr_b16 v[78:79], v15 offset:2560
  ds_read_b64_tr_b16 v[68:69], v15 offset:0
  ds_read_b64_tr_b16 v[70:71], v15 offset:512
  v_xor_b32 v14, 32, v13
  ds_read_b128 v[80:83], v14
  ds_read_b64_tr_b16 v[88:89], v15 offset:7168
  ds_read_b64_tr_b16 v[90:91], v15 offset:7680
  ds_read_b64_tr_b16 v[92:93], v15 offset:8192
  ds_read_b64_tr_b16 v[94:95], v15 offset:8704
  ds_read_b64_tr_b16 v[84:85], v15 offset:6144
  ds_read_b64_tr_b16 v[86:87], v15 offset:6656
  s_add_u32 s56, s58, s55
  s_add_u32 s57, s56, 1
  s_and_b32 s57, s57, 7
  s_mul_i32 s62, s57, 196608
  s_add_u32 s62, s62, 98304
  s_add_u32 s56, s56, 2
  s_and_b32 s56, s56, 7
  s_lshl_b32 s61, s56, 7
  v_add_u32 v15, 12288, v15
  v_xor_b32 v14, 64, v13
  s_waitcnt lgkmcnt(7)
  v_mfma_f32_32x32x16_bf16 v[32:47], v[64:67], v[72:75], v[32:47]
  v_mfma_f32_32x32x16_bf16 v[48:63], v[64:67], v[76:79], v[48:63]
  v_mfma_f32_32x32x16_bf16 v[16:31], v[68:71], v[64:67], v[16:31]
  s_mul_i32 s62, s56, 196608
  s_add_u32 s64, s60, s66
  s_waitcnt lgkmcnt(0) vmcnt(10)
  s_barrier
  v_mfma_f32_32x32x16_bf16 v[32:47], v[80:83], v[88:91], v[32:47]
  ds_read_b128 v[96:99], v14
  ds_read_b64_tr_b16 v[104:105], v15 offset:1024
  ds_read_b64_tr_b16 v[106:107], v15 offset:1536
  v_mfma_f32_32x32x16_bf16 v[48:63], v[80:83], v[92:95], v[48:63]
  ds_read_b64_tr_b16 v[108:109], v15 offset:2048
  ds_read_b64_tr_b16 v[110:111], v15 offset:2560
  ds_read_b64_tr_b16 v[100:101], v15 offset:0
  v_mfma_f32_32x32x16_bf16 v[16:31], v[84:87], v[80:83], v[16:31]
  ds_read_b64_tr_b16 v[102:103], v15 offset:512
  v_xor_b32 v14, 0x60, v13
  ds_read_b128 v[112:115], v14
  ds_read_b64_tr_b16 v[120:121], v15 offset:7168
  ds_read_b64_tr_b16 v[122:123], v15 offset:7680
  ds_read_b64_tr_b16 v[124:125], v15 offset:8192
  ds_read_b64_tr_b16 v[126:127], v15 offset:8704
  ds_read_b64_tr_b16 v[116:117], v15 offset:6144
  ds_read_b64_tr_b16 v[118:119], v15 offset:6656
  s_mov_b32 m0, s64
  s_nop 0
  buffer_load_dwordx4 v8, s[48:51], s62 offen lds
  s_add_u32 s45, s59, s65
  s_xor_b32 s60, s60, 24576
  s_add_u32 s59, s59, 8192
  s_cmp_eq_u32 s59, 24576
  s_cselect_b32 s59, 0, s59
  v_add_u32 v15, s60, v12
  v_add_u32 v13, s59, v10
  s_add_u32 s58, s58, 1
  s_waitcnt lgkmcnt(7)
  v_mfma_f32_32x32x16_bf16 v[32:47], v[96:99], v[104:107], v[32:47]
  buffer_load_dwordx4 v8, s[48:51], s62 offen offset:1024 lds
  v_mfma_f32_32x32x16_bf16 v[48:63], v[96:99], v[108:111], v[48:63]
  buffer_load_dwordx4 v8, s[48:51], s62 offen offset:2048 lds
  v_mfma_f32_32x32x16_bf16 v[16:31], v[100:103], v[96:99], v[16:31]
  s_add_u32 s64, s64, 12288
  s_waitcnt lgkmcnt(0) vmcnt(8)
  s_barrier
  v_mfma_f32_32x32x16_bf16 v[32:47], v[112:115], v[120:123], v[32:47]
  ds_read_b128 v[64:67], v13
  ds_read_b64_tr_b16 v[72:73], v15 offset:1024
  ds_read_b64_tr_b16 v[74:75], v15 offset:1536
  v_mfma_f32_32x32x16_bf16 v[48:63], v[112:115], v[124:127], v[48:63]
  ds_read_b64_tr_b16 v[76:77], v15 offset:2048
  ds_read_b64_tr_b16 v[78:79], v15 offset:2560
  ds_read_b64_tr_b16 v[68:69], v15 offset:0
  v_mfma_f32_32x32x16_bf16 v[16:31], v[116:119], v[112:115], v[16:31]
  ds_read_b64_tr_b16 v[70:71], v15 offset:512
LA_loop:
  v_xor_b32 v14, 32, v13
  ds_read_b128 v[80:83], v14
  ds_read_b64_tr_b16 v[88:89], v15 offset:7168
  ds_read_b64_tr_b16 v[90:91], v15 offset:7680
  ds_read_b64_tr_b16 v[92:93], v15 offset:8192
  ds_read_b64_tr_b16 v[94:95], v15 offset:8704
  ds_read_b64_tr_b16 v[84:85], v15 offset:6144
  ds_read_b64_tr_b16 v[86:87], v15 offset:6656
  s_add_u32 s56, s58, s55
  s_add_u32 s57, s56, 1
  s_and_b32 s57, s57, 7
  s_mul_i32 s62, s57, 196608
  s_add_u32 s62, s62, 98304
  s_add_u32 s56, s56, 2
  s_and_b32 s56, s56, 7
  s_lshl_b32 s61, s56, 7
  s_mov_b32 m0, s64
  s_nop 0
  buffer_load_dwordx4 v8, s[48:51], s62 offen lds
  v_add_u32 v15, 12288, v15
  v_xor_b32 v14, 64, v13
  s_waitcnt lgkmcnt(7)
  v_mfma_f32_32x32x16_bf16 v[32:47], v[64:67], v[72:75], v[32:47]
  buffer_load_dwordx4 v8, s[48:51], s62 offen offset:1024 lds
  buffer_load_dwordx4 v8, s[48:51], s62 offen offset:2048 lds
  v_mfma_f32_32x32x16_bf16 v[48:63], v[64:67], v[76:79], v[48:63]
  s_mov_b32 m0, s45
  s_nop 0
  buffer_load_dwordx4 v6, s[72:75], s61 offen lds
  s_add_u32 m0, s45, 1024
  s_nop 0
  buffer_load_dwordx4 v7, s[72:75], s61 offen lds
  v_mfma_f32_32x32x16_bf16 v[16:31], v[68:71], v[64:67], v[16:31]
  s_mul_i32 s62, s56, 196608
  s_add_u32 s64, s60, s66
  s_waitcnt lgkmcnt(0) vmcnt(10)
  s_barrier
  v_mfma_f32_32x32x16_bf16 v[32:47], v[80:83], v[88:91], v[32:47]
  ds_read_b128 v[96:99], v14
  ds_read_b64_tr_b16 v[104:105], v15 offset:1024
  ds_read_b64_tr_b16 v[106:107], v15 offset:1536
  v_mfma_f32_32x32x16_bf16 v[48:63], v[80:83], v[92:95], v[48:63]
  ds_read_b64_tr_b16 v[108:109], v15 offset:2048
  ds_read_b64_tr_b16 v[110:111], v15 offset:2560
  ds_read_b64_tr_b16 v[100:101], v15 offset:0
  v_mfma_f32_32x32x16_bf16 v[16:31], v[84:87], v[80:83], v[16:31]
  ds_read_b64_tr_b16 v[102:103], v15 offset:512
  v_xor_b32 v14, 0x60, v13
  ds_read_b128 v[112:115], v14
  ds_read_b64_tr_b16 v[120:121], v15 offset:7168
  ds_read_b64_tr_b16 v[122:123], v15 offset:7680
  ds_read_b64_tr_b16 v[124:125], v15 offset:8192
  ds_read_b64_tr_b16 v[126:127], v15 offset:8704
  ds_read_b64_tr_b16 v[116:117], v15 offset:6144
  ds_read_b64_tr_b16 v[118:119], v15 offset:6656
  s_mov_b32 m0, s64
  s_nop 0
  buffer_load_dwordx4 v8, s[48:51], s62 offen lds
  s_add_u32 s45, s59, s65
  s_xor_b32 s60, s60, 24576
  s_add_u32 s59, s59, 8192
  s_cmp_eq_u32 s59, 24576
  s_cselect_b32 s59, 0, s59
  v_add_u32 v15, s60, v12
  v_add_u32 v13, s59, v10
  s_add_u32 s58, s58, 1
  s_waitcnt lgkmcnt(7)
  v_mfma_f32_32x32x16_bf16 v[32:47], v[96:99], v[104:107], v[32:47]
  buffer_load_dwordx4 v8, s[48:51], s62 offen offset:1024 lds
  v_mfma_f32_32x32x16_bf16 v[48:63], v[96:99], v[108:111], v[48:63]
  buffer_load_dwordx4 v8, s[48:51], s62 offen offset:2048 lds
  v_mfma_f32_32x32x16_bf16 v[16:31], v[100:103], v[96:99], v[16:31]
  s_add_u32 s64, s64, 12288
  s_waitcnt lgkmcnt(0) vmcnt(8)
  s_barrier
  v_mfma_f32_32x32x16_bf16 v[32:47], v[112:115], v[120:123], v[32:47]
  ds_read_b128 v[64:67], v13
  ds_read_b64_tr_b16 v[72:73], v15 offset:1024
  ds_read_b64_tr_b16 v[74:75], v15 offset:1536
  v_mfma_f32_32x32x16_bf16 v[48:63], v[112:115], v[124:127], v[48:63]
  ds_read_b64_tr_b16 v[76:77], v15 offset:2048
  ds_read_b64_tr_b16 v[78:79], v15 offset:2560
  ds_read_b64_tr_b16 v[68:69], v15 offset:0
  v_mfma_f32_32x32x16_bf16 v[16:31], v[116:119], v[112:115], v[16:31]
  ds_read_b64_tr_b16 v[70:71], v15 offset:512
  s_cmp_lt_u32 s58, 6
  s_cbranch_scc1 LA_loop
  v_xor_b32 v14, 32, v13
  ds_read_b128 v[80:83], v14
  ds_read_b64_tr_b16 v[88:89], v15 offset:7168
  ds_read_b64_tr_b16 v[90:91], v15 offset:7680
  ds_read_b64_tr_b16 v[92:93], v15 offset:8192
  ds_read_b64_tr_b16 v[94:95], v15 offset:8704
  ds_read_b64_tr_b16 v[84:85], v15 offset:6144
  ds_read_b64_tr_b16 v[86:87], v15 offset:6656
  s_add_u32 s56, s58, s55
  s_add_u32 s57, s56, 1
  s_and_b32 s57, s57, 7
  s_mul_i32 s62, s57, 196608
  s_add_u32 s62, s62, 98304
  s_add_u32 s56, s56, 2
  s_and_b32 s56, s56, 7
  s_lshl_b32 s61, s56, 7
  s_mov_b32 m0, s64
  s_nop 0
  buffer_load_dwordx4 v8, s[48:51], s62 offen lds
  v_add_u32 v15, 12288, v15
  v_xor_b32 v14, 64, v13
  s_waitcnt lgkmcnt(7)
  v_mfma_f32_32x32x16_bf16 v[32:47], v[64:67], v[72:75], v[32:47]
  buffer_load_dwordx4 v8, s[48:51], s62 offen offset:1024 lds
  buffer_load_dwordx4 v8, s[48:51], s62 offen offset:2048 lds
  v_mfma_f32_32x32x16_bf16 v[48:63], v[64:67], v[76:79], v[48:63]
  s_add_u32 s63, s67, 0
  s_and_b32 s63, s63, 15
  s_add_u32 m0, s65, 16384
  s_lshl_b32 s63, s63, 13
  s_add_u32 s63, s63, s12
  buffer_load_dwordx4 v9, s[68:71], s63 offen lds
  s_add_u32 s63, s67, 0
  s_and_b32 s63, s63, 15
  s_add_u32 m0, s65, 17408
  s_lshl_b32 s63, s63, 13
  s_add_u32 s63, s63, s13
  buffer_load_dwordx4 v9, s[68:71], s63 offen lds
  v_mfma_f32_32x32x16_bf16 v[16:31], v[68:71], v[64:67], v[16:31]
  s_mul_i32 s62, s56, 196608
  s_add_u32 s64, s60, s66
  s_waitcnt lgkmcnt(0) vmcnt(10)
  s_barrier
  v_mfma_f32_32x32x16_bf16 v[32:47], v[80:83], v[88:91], v[32:47]
  ds_read_b128 v[96:99], v14
  ds_read_b64_tr_b16 v[104:105], v15 offset:1024
  ds_read_b64_tr_b16 v[106:107], v15 offset:1536
  v_mfma_f32_32x32x16_bf16 v[48:63], v[80:83], v[92:95], v[48:63]
  ds_read_b64_tr_b16 v[108:109], v15 offset:2048
  ds_read_b64_tr_b16 v[110:111], v15 offset:2560
  ds_read_b64_tr_b16 v[100:101], v15 offset:0
  v_mfma_f32_32x32x16_bf16 v[16:31], v[84:87], v[80:83], v[16:31]
  ds_read_b64_tr_b16 v[102:103], v15 offset:512
  v_xor_b32 v14, 0x60, v13
  ds_read_b128 v[112:115], v14
  ds_read_b64_tr_b16 v[120:121], v15 offset:7168
  ds_read_b64_tr_b16 v[122:123], v15 offset:7680
  ds_read_b64_tr_b16 v[124:125], v15 offset:8192
  ds_read_b64_tr_b16 v[126:127], v15 offset:8704
  ds_read_b64_tr_b16 v[116:117], v15 offset:6144
  ds_read_b64_tr_b16 v[118:119], v15 offset:6656
  global_load_dword v5, v4, s[38:39] sc1
  s_add_u32 s45, s59, s65
  s_xor_b32 s60, s60, 24576
  s_add_u32 s59, s59, 8192
  s_cmp_eq_u32 s59, 24576
  s_cselect_b32 s59, 0, s59
  v_add_u32 v15, s60, v12
  v_add_u32 v13, s59, v10
  s_add_u32 s58, s58, 1
  s_waitcnt lgkmcnt(7)
  v_mfma_f32_32x32x16_bf16 v[32:47], v[96:99], v[104:107], v[32:47]
  s_add_u32 s63, s67, 1
  s_and_b32 s63, s63, 15
  s_add_u32 m0, s66, 0
  s_lshl_b32 s63, s63, 13
  s_add_u32 s63, s63, s12
  buffer_load_dwordx4 v9, s[68:71], s63 offen lds
  v_mfma_f32_32x32x16_bf16 v[48:63], v[96:99], v[108:111], v[48:63]
  s_add_u32 s63, s67, 1
  s_and_b32 s63, s63, 15
  s_add_u32 m0, s66, 1024
  s_lshl_b32 s63, s63, 13
  s_add_u32 s63, s63, s13
  buffer_load_dwordx4 v9, s[68:71], s63 offen lds
  v_mfma_f32_32x32x16_bf16 v[16:31], v[100:103], v[96:99], v[16:31]
  s_add_u32 s63, s67, 2
  s_and_b32 s63, s63, 15
  s_add_u32 m0, s66, 2048
  s_lshl_b32 s63, s63, 13
  s_add_u32 s63, s63, s12
  buffer_load_dwordx4 v9, s[68:71], s63 offen lds
  s_add_u32 s64, s64, 12288
  s_waitcnt lgkmcnt(0) vmcnt(8)
  s_barrier
  v_mfma_f32_32x32x16_bf16 v[32:47], v[112:115], v[120:123], v[32:47]
  ds_read_b128 v[64:67], v13
  ds_read_b64_tr_b16 v[72:73], v15 offset:1024
  ds_read_b64_tr_b16 v[74:75], v15 offset:1536
  v_mfma_f32_32x32x16_bf16 v[48:63], v[112:115], v[124:127], v[48:63]
  ds_read_b64_tr_b16 v[76:77], v15 offset:2048
  ds_read_b64_tr_b16 v[78:79], v15 offset:2560
  ds_read_b64_tr_b16 v[68:69], v15 offset:0
  v_mfma_f32_32x32x16_bf16 v[16:31], v[116:119], v[112:115], v[16:31]
  ds_read_b64_tr_b16 v[70:71], v15 offset:512
  v_xor_b32 v14, 32, v13
  ds_read_b128 v[80:83], v14
  ds_read_b64_tr_b16 v[88:89], v15 offset:7168
  ds_read_b64_tr_b16 v[90:91], v15 offset:7680
  ds_read_b64_tr_b16 v[92:93], v15 offset:8192
  ds_read_b64_tr_b16 v[94:95], v15 offset:8704
  ds_read_b64_tr_b16 v[84:85], v15 offset:6144
  ds_read_b64_tr_b16 v[86:87], v15 offset:6656
  s_add_u32 s56, s58, s55
  s_add_u32 s57, s56, 1
  s_and_b32 s57, s57, 7
  s_mul_i32 s62, s57, 196608
  s_add_u32 s62, s62, 98304
  s_add_u32 s56, s56, 2
  s_and_b32 s56, s56, 7
  s_lshl_b32 s61, s56, 7
  s_add_u32 s63, s67, 2
  s_and_b32 s63, s63, 15
  s_add_u32 m0, s66, 12288
  s_lshl_b32 s63, s63, 13
  s_add_u32 s63, s63, s13
  buffer_load_dwordx4 v9, s[68:71], s63 offen lds
  v_add_u32 v15, 12288, v15
  v_xor_b32 v14, 64, v13
  s_waitcnt lgkmcnt(7)
  v_mfma_f32_32x32x16_bf16 v[32:47], v[64:67], v[72:75], v[32:47]
  s_add_u32 s63, s67, 3
  s_and_b32 s63, s63, 15
  s_add_u32 m0, s66, 13312
  s_lshl_b32 s63, s63, 13
  s_add_u32 s63, s63, s12
  buffer_load_dwordx4 v9, s[68:71], s63 offen lds
  s_add_u32 s63, s67, 3
  s_and_b32 s63, s63, 15
  s_add_u32 m0, s66, 14336
  s_lshl_b32 s63, s63, 13
  s_add_u32 s63, s63, s13
  buffer_load_dwordx4 v9, s[68:71], s63 offen lds
  v_mfma_f32_32x32x16_bf16 v[48:63], v[64:67], v[76:79], v[48:63]
  s_add_u32 s63, s67, 4
  s_and_b32 s63, s63, 15
  s_add_u32 m0, s65, 0
  s_lshl_b32 s63, s63, 13
  s_add_u32 s63, s63, s12
  buffer_load_dwordx4 v9, s[68:71], s63 offen lds
  s_add_u32 s63, s67, 4
  s_and_b32 s63, s63, 15
  s_add_u32 m0, s65, 1024
  s_lshl_b32 s63, s63, 13
  s_add_u32 s63, s63, s13
  buffer_load_dwordx4 v9, s[68:71], s63 offen lds
  v_mfma_f32_32x32x16_bf16 v[16:31], v[68:71], v[64:67], v[16:31]
  s_mul_i32 s62, s56, 196608
  s_add_u32 s64, s60, s66
  s_waitcnt lgkmcnt(0) vmcnt(10)
  s_barrier
  v_mfma_f32_32x32x16_bf16 v[32:47], v[80:83], v[88:91], v[32:47]
  ds_read_b128 v[96:99], v14
  ds_read_b64_tr_b16 v[104:105], v15 offset:1024
  ds_read_b64_tr_b16 v[106:107], v15 offset:1536
  v_mfma_f32_32x32x16_bf16 v[48:63], v[80:83], v[92:95], v[48:63]
  ds_read_b64_tr_b16 v[108:109], v15 offset:2048
  ds_read_b64_tr_b16 v[110:111], v15 offset:2560
  ds_read_b64_tr_b16 v[100:101], v15 offset:0
  v_mfma_f32_32x32x16_bf16 v[16:31], v[84:87], v[80:83], v[16:31]
  ds_read_b64_tr_b16 v[102:103], v15 offset:512
  v_xor_b32 v14, 0x60, v13
  ds_read_b128 v[112:115], v14
  ds_read_b64_tr_b16 v[120:121], v15 offset:7168
  ds_read_b64_tr_b16 v[122:123], v15 offset:7680
  ds_read_b64_tr_b16 v[124:125], v15 offset:8192
  ds_read_b64_tr_b16 v[126:127], v15 offset:8704
  ds_read_b64_tr_b16 v[116:117], v15 offset:6144
  ds_read_b64_tr_b16 v[118:119], v15 offset:6656
  s_add_u32 s63, s67, 5
  s_and_b32 s63, s63, 15
  s_add_u32 m0, s66, 24576
  s_lshl_b32 s63, s63, 13
  s_add_u32 s63, s63, s12
  buffer_load_dwordx4 v9, s[68:71], s63 offen lds
  s_waitcnt lgkmcnt(7)
  v_mfma_f32_32x32x16_bf16 v[32:47], v[96:99], v[104:107], v[32:47]
  s_add_u32 s63, s67, 5
  s_and_b32 s63, s63, 15
  s_add_u32 m0, s66, 25600
  s_lshl_b32 s63, s63, 13
  s_add_u32 s63, s63, s13
  buffer_load_dwordx4 v9, s[68:71], s63 offen lds
  v_mfma_f32_32x32x16_bf16 v[48:63], v[96:99], v[108:111], v[48:63]
  s_add_u32 s63, s67, 6
  s_and_b32 s63, s63, 15
  s_add_u32 m0, s66, 26624
  s_lshl_b32 s63, s63, 13
  s_add_u32 s63, s63, s12
  buffer_load_dwordx4 v9, s[68:71], s63 offen lds
  v_mfma_f32_32x32x16_bf16 v[16:31], v[100:103], v[96:99], v[16:31]
  s_waitcnt lgkmcnt(0)
  v_mfma_f32_32x32x16_bf16 v[32:47], v[112:115], v[120:123], v[32:47]
  v_mfma_f32_32x32x16_bf16 v[48:63], v[112:115], v[124:127], v[48:63]
  v_mfma_f32_32x32x16_bf16 v[16:31], v[116:119], v[112:115], v[16:31]
  v_mov_b32 v12, v244
  v_mov_b32 v13, v245
  v_mov_b32 v14, v246
  v_mov_b32 v15, v247
  s_nop 5
  v_fma_f32 v224, v32, s42, v3
  v_fma_f32 v225, v33, s42, v3
  v_fma_f32 v226, v34, s42, v3
  v_fma_f32 v227, v35, s42, v3
  v_fma_f32 v228, v36, s42, v3
  v_fma_f32 v229, v37, s42, v3
  v_fma_f32 v230, v38, s42, v3
  v_fma_f32 v231, v39, s42, v3
  v_fma_f32 v232, v40, s42, v3
  v_fma_f32 v233, v41, s42, v3
  v_fma_f32 v234, v42, s42, v3
  v_fma_f32 v235, v43, s42, v3
  v_fma_f32 v236, v44, s42, v3
  v_fma_f32 v237, v45, s42, v3
  v_fma_f32 v238, v46, s42, v3
  v_fma_f32 v239, v47, s42, v3
  v_exp_f32 v224, v224 clamp
  v_exp_f32 v225, v225 clamp
  v_exp_f32 v226, v226 clamp
  v_exp_f32 v227, v227 clamp
  v_exp_f32 v228, v228 clamp
  v_exp_f32 v229, v229 clamp
  v_exp_f32 v230, v230 clamp
  v_exp_f32 v231, v231 clamp
  v_exp_f32 v232, v232 clamp
  v_exp_f32 v233, v233 clamp
  v_exp_f32 v234, v234 clamp
  v_exp_f32 v235, v235 clamp
  v_exp_f32 v236, v236 clamp
  v_exp_f32 v237, v237 clamp
  v_exp_f32 v238, v238 clamp
  v_exp_f32 v239, v239 clamp
  v_cvt_pk_bf16_f32 v72, v48, v49
  v_cvt_pk_bf16_f32 v73, v50, v51
  v_cvt_pk_bf16_f32 v74, v52, v53
  v_cvt_pk_bf16_f32 v75, v54, v55
  v_cvt_pk_bf16_f32 v76, v56, v57
  v_cvt_pk_bf16_f32 v77, v58, v59
  v_cvt_pk_bf16_f32 v78, v60, v61
  v_cvt_pk_bf16_f32 v79, v62, v63
  v_max_f32 v32, s43, v32
  v_max_f32 v33, s43, v33
  v_max_f32 v34, s43, v34
  v_max_f32 v35, s43, v35
  v_max_f32 v36, s43, v36
  v_max_f32 v37, s43, v37
  v_max_f32 v38, s43, v38
  v_max_f32 v39, s43, v39
  v_max_f32 v40, s43, v40
  v_max_f32 v41, s43, v41
  v_max_f32 v42, s43, v42
  v_max_f32 v43, s43, v43
  v_max_f32 v44, s43, v44
  v_max_f32 v45, s43, v45
  v_max_f32 v46, s43, v46
  v_max_f32 v47, s43, v47
  v_pk_add_f32 v[32:33], v[32:33], v[224:225]
  v_pk_add_f32 v[34:35], v[34:35], v[226:227]
  v_pk_add_f32 v[36:37], v[36:37], v[228:229]
  v_pk_add_f32 v[38:39], v[38:39], v[230:231]
  v_pk_add_f32 v[40:41], v[40:41], v[232:233]
  v_pk_add_f32 v[42:43], v[42:43], v[234:235]
  v_pk_add_f32 v[44:45], v[44:45], v[236:237]
  v_pk_add_f32 v[46:47], v[46:47], v[238:239]
  v_cvt_pk_bf16_f32 v64, v32, v33
  v_cvt_pk_bf16_f32 v65, v34, v35
  v_cvt_pk_bf16_f32 v66, v36, v37
  v_cvt_pk_bf16_f32 v67, v38, v39
  v_cvt_pk_bf16_f32 v68, v40, v41
  v_cvt_pk_bf16_f32 v69, v42, v43
  v_cvt_pk_bf16_f32 v70, v44, v45
  v_cvt_pk_bf16_f32 v71, v46, v47
  v_mfma_f32_32x32x16_bf16 v[96:111], v[64:67], v[72:75], 0
  s_nop 0
  v_mfma_f32_32x32x16_bf16 v[96:111], v[68:71], v[76:79], v[96:111]
  v_mfma_f32_32x32x16_bf16 v[48:63], v[208:211], v[64:67], 0
  v_mfma_f32_32x32x16_bf16 v[48:63], v[208:211], v[68:71], v[48:63]
  v_fma_f32 v224, v16, s42, v3
  v_fma_f32 v225, v17, s42, v3
  v_fma_f32 v226, v18, s42, v3
  v_fma_f32 v227, v19, s42, v3
  v_fma_f32 v228, v20, s42, v3
  v_fma_f32 v229, v21, s42, v3
  v_fma_f32 v230, v22, s42, v3
  v_fma_f32 v231, v23, s42, v3
  v_fma_f32 v232, v24, s42, v3
  v_fma_f32 v233, v25, s42, v3
  v_fma_f32 v234, v26, s42, v3
  v_fma_f32 v235, v27, s42, v3
  v_fma_f32 v236, v28, s42, v3
  v_fma_f32 v237, v29, s42, v3
  v_fma_f32 v238, v30, s42, v3
  v_fma_f32 v239, v31, s42, v3
  v_exp_f32 v224, v224 clamp
  v_exp_f32 v225, v225 clamp
  v_exp_f32 v226, v226 clamp
  v_exp_f32 v227, v227 clamp
  v_exp_f32 v228, v228 clamp
  v_exp_f32 v229, v229 clamp
  v_exp_f32 v230, v230 clamp
  v_exp_f32 v231, v231 clamp
  v_exp_f32 v232, v232 clamp
  v_exp_f32 v233, v233 clamp
  v_exp_f32 v234, v234 clamp
  v_exp_f32 v235, v235 clamp
  v_exp_f32 v236, v236 clamp
  v_exp_f32 v237, v237 clamp
  v_exp_f32 v238, v238 clamp
  v_exp_f32 v239, v239 clamp
  v_cndmask_b32 v96, v96, v104, s[14:15]
  v_cndmask_b32 v97, v97, v105, s[14:15]
  v_cndmask_b32 v98, v98, v106, s[14:15]
  v_cndmask_b32 v99, v99, v107, s[14:15]
  v_cndmask_b32 v100, v100, v108, s[14:15]
  v_cndmask_b32 v101, v101, v109, s[14:15]
  v_cndmask_b32 v102, v102, v110, s[14:15]
  v_cndmask_b32 v103, v103, v111, s[14:15]
  ds_write_b128 v240, v[96:99]
  ds_write_b128 v240, v[100:103] offset:512
  s_mov_b32 s63, 0
  s_waitcnt vmcnt(11)
LA_zpoll:
  v_cmp_eq_u32 s[56:57], 0, v5
  s_nop 0
  s_cmp_eq_u64 s[56:57], 0
  s_cbranch_scc1 LA_zok
  s_add_u32 s63, s63, 1
  s_cmp_gt_u32 s63, 262144
  s_cbranch_scc1 LA_zok
  s_sleep 2
  global_load_dword v5, v4, s[38:39] sc1
  s_waitcnt vmcnt(0)
  s_branch LA_zpoll
LA_zok:
  s_mov_b32 exec_hi, 0
  global_atomic_add_f32 v241, v48, s[40:41]
  s_mov_b32 exec_hi, -1
  s_waitcnt lgkmcnt(0)
  s_barrier
  ds_read_b32 v96, v242 offset:0
  ds_read_b32 v97, v242 offset:2048
  ds_read_b32 v98, v242 offset:1024
  ds_read_b32 v99, v242 offset:3072
  ds_read_b32 v100, v242 offset:4096
  ds_read_b32 v101, v242 offset:6144
  ds_read_b32 v102, v242 offset:5120
  ds_read_b32 v103, v242 offset:7168
  s_waitcnt lgkmcnt(6)
  v_add_f32 v96, v96, v97
  global_atomic_add_f32 v243, v96, s[40:41] offset:-4096
  s_waitcnt lgkmcnt(4)
  v_add_f32 v98, v98, v99
  global_atomic_add_f32 v243, v98, s[40:41] offset:-3072
  s_waitcnt lgkmcnt(2)
  v_add_f32 v100, v100, v101
  global_atomic_add_f32 v243, v100, s[40:41] offset:0
  s_waitcnt lgkmcnt(0)
  v_add_f32 v102, v102, v103
  global_atomic_add_f32 v243, v102, s[40:41] offset:1024
  v_max_f32 v16, s43, v16
  v_max_f32 v17, s43, v17
  v_max_f32 v18, s43, v18
  v_max_f32 v19, s43, v19
  v_max_f32 v20, s43, v20
  v_max_f32 v21, s43, v21
  v_max_f32 v22, s43, v22
  v_max_f32 v23, s43, v23
  v_max_f32 v24, s43, v24
  v_max_f32 v25, s43, v25
  v_max_f32 v26, s43, v26
  v_max_f32 v27, s43, v27
  v_max_f32 v28, s43, v28
  v_max_f32 v29, s43, v29
  v_max_f32 v30, s43, v30
  v_max_f32 v31, s43, v31
  v_pk_add_f32 v[16:17], v[16:17], v[224:225]
  v_pk_add_f32 v[18:19], v[18:19], v[226:227]
  v_pk_add_f32 v[20:21], v[20:21], v[228:229]
  v_pk_add_f32 v[22:23], v[22:23], v[230:231]
  v_pk_add_f32 v[24:25], v[24:25], v[232:233]
  v_pk_add_f32 v[26:27], v[26:27], v[234:235]
  v_pk_add_f32 v[28:29], v[28:29], v[236:237]
  v_pk_add_f32 v[30:31], v[30:31], v[238:239]
  v_cvt_pk_bf16_f32 v80, v16, v17
  v_cvt_pk_bf16_f32 v81, v18, v19
  v_cvt_pk_bf16_f32 v82, v20, v21
  v_cvt_pk_bf16_f32 v83, v22, v23
  v_cvt_pk_bf16_f32 v84, v24, v25
  v_cvt_pk_bf16_f32 v85, v26, v27
  v_cvt_pk_bf16_f32 v86, v28, v29
  v_cvt_pk_bf16_f32 v87, v30, v31
  global_store_dwordx4 v248, v[80:83], s[40:41] sc1
  global_store_dwordx4 v248, v[84:87], s[40:41] offset:1024 sc1
  s_waitcnt vmcnt(7)
  ds_read_b64_tr_b16 v[128:129], v14 offset:16384
  ds_read_b64_tr_b16 v[132:133], v15 offset:16384
  ds_read_b64_tr_b16 v[136:137], v14 offset:17408
  ds_read_b64_tr_b16 v[140:141], v15 offset:17408
  ds_read_b64_tr_b16 v[130:131], v12 offset:0
  ds_read_b64_tr_b16 v[134:135], v13 offset:0
  ds_read_b64_tr_b16 v[138:139], v12 offset:1024
  ds_read_b64_tr_b16 v[142:143], v13 offset:1024
  ds_read_b64_tr_b16 v[144:145], v12 offset:2048
  ds_read_b64_tr_b16 v[148:149], v13 offset:2048
  ds_read_b64_tr_b16 v[152:153], v12 offset:12288
  ds_read_b64_tr_b16 v[156:157], v13 offset:12288
  ds_read_b64_tr_b16 v[146:147], v12 offset:13312
  ds_read_b64_tr_b16 v[150:151], v13 offset:13312
  ds_read_b64_tr_b16 v[154:155], v12 offset:14336
  ds_read_b64_tr_b16 v[158:159], v13 offset:14336
  ds_read_b64_tr_b16 v[160:161], v14 offset:0
  ds_read_b64_tr_b16 v[164:165], v15 offset:0
  ds_read_b64_tr_b16 v[168:169], v14 offset:1024
  ds_read_b64_tr_b16 v[172:173], v15 offset:1024
  ds_read_b64_tr_b16 v[162:163], v12 offset:24576
  ds_read_b64_tr_b16 v[166:167], v13 offset:24576
  ds_read_b64_tr_b16 v[170:171], v12 offset:25600
  ds_read_b64_tr_b16 v[174:175], v13 offset:25600
  ds_read_b64_tr_b16 v[176:177], v12 offset:26624
  ds_read_b64_tr_b16 v[180:181], v13 offset:26624
  s_waitcnt lgkmcnt(0)
  s_add_u32 s63, s67, 6
  s_and_b32 s63, s63, 15
  s_add_u32 m0, s66, 36864
  s_lshl_b32 s63, s63, 13
  s_add_u32 s63, s63, s13
  buffer_load_dwordx4 v9, s[68:71], s63 offen lds
  s_add_u32 s63, s67, 7
  s_and_b32 s63, s63, 15
  s_add_u32 m0, s66, 37888
  s_lshl_b32 s63, s63, 13
  s_add_u32 s63, s63, s12
  buffer_load_dwordx4 v9, s[68:71], s63 offen lds
  s_add_u32 s63, s67, 7
  s_and_b32 s63, s63, 15
  s_add_u32 m0, s66, 38912
  s_lshl_b32 s63, s63, 13
  s_add_u32 s63, s63, s13
  buffer_load_dwordx4 v9, s[68:71], s63 offen lds
  s_add_u32 s63, s67, 8
  s_and_b32 s63, s63, 15
  s_add_u32 m0, s65, 8192
  s_lshl_b32 s63, s63, 13
  s_add_u32 s63, s63, s12
  buffer_load_dwordx4 v9, s[68:71], s63 offen lds
  s_waitcnt vmcnt(4)
  s_barrier
  s_cmp_lg_u32 s52, 0
  s_cbranch_scc1 LA_nosig
  s_mov_b64 exec, 1
  global_atomic_add v8, v249, v212, s[40:41] sc0
  s_mov_b64 exec, -1
  s_cmp_lg_u32 s52, 0
  s_cbranch_scc1 LA_nl
  s_waitcnt vmcnt(0)
  v_readfirstlane_b32 s63, v8
  s_nop 0
  s_cmp_lg_u32 s63, 31
  s_cbranch_scc1 LA_nl
  s_mov_b64 exec, 0xff
  global_store_dword v250, v212, s[40:41] sc1
  s_mov_b64 exec, -1
LA_nl:
LA_nosig:
  s_add_u32 s58, s67, 8
  s_and_b32 s58, s58, 15
  s_add_u32 m0, s65, 9216
  s_lshl_b32 s58, s58, 13
  s_add_u32 s58, s58, s13
  buffer_load_dwordx4 v9, s[68:71], s58 offen lds
  s_add_u32 s58, s67, 9
  s_and_b32 s58, s58, 15
  s_add_u32 m0, s65, 16384
  s_lshl_b32 s58, s58, 13
  s_add_u32 s58, s58, s12
  buffer_load_dwordx4 v9, s[68:71], s58 offen lds
  s_add_u32 s58, s67, 9
  s_and_b32 s58, s58, 15
  s_add_u32 m0, s65, 17408
  s_lshl_b32 s58, s58, 13
  s_add_u32 s58, s58, s13
  buffer_load_dwordx4 v9, s[68:71], s58 offen lds
  s_add_u32 s58, s67, 10
  s_and_b32 s58, s58, 15
  s_add_u32 m0, s66, 0
  s_lshl_b32 s58, s58, 13
  s_add_u32 s58, s58, s12
  buffer_load_dwordx4 v9, s[68:71], s58 offen lds
  s_add_u32 s58, s67, 10
  s_and_b32 s58, s58, 15
  s_add_u32 m0, s66, 1024
  s_lshl_b32 s58, s58, 13
  s_add_u32 s58, s58, s13
  buffer_load_dwordx4 v9, s[68:71], s58 offen lds
  s_add_u32 s58, s67, 11
  s_and_b32 s58, s58, 15
  s_add_u32 m0, s66, 2048
  s_lshl_b32 s58, s58, 13
  s_add_u32 s58, s58, s12
  buffer_load_dwordx4 v9, s[68:71], s58 offen lds
  s_add_u32 s58, s67, 11
  s_and_b32 s58, s58, 15
  s_add_u32 m0, s66, 12288
  s_lshl_b32 s58, s58, 13
  s_add_u32 s58, s58, s13
  buffer_load_dwordx4 v9, s[68:71], s58 offen lds
  s_add_u32 s58, s67, 12
  s_and_b32 s58, s58, 15
  s_add_u32 m0, s66, 13312
  s_lshl_b32 s58, s58, 13
  s_add_u32 s58, s58, s12
  buffer_load_dwordx4 v9, s[68:71], s58 offen lds
  s_add_u32 s58, s67, 12
  s_and_b32 s58, s58, 15
  s_add_u32 m0, s66, 14336
  s_lshl_b32 s58, s58, 13
  s_add_u32 s58, s58, s13
  buffer_load_dwordx4 v9, s[68:71], s58 offen lds
  s_add_u32 s58, s67, 13
  s_and_b32 s58, s58, 15
  s_add_u32 m0, s65, 0
  s_lshl_b32 s58, s58, 13
  s_add_u32 s58, s58, s12
  buffer_load_dwordx4 v9, s[68:71], s58 offen lds
  s_add_u32 s58, s67, 13
  s_and_b32 s58, s58, 15
  s_add_u32 m0, s65, 1024
  s_lshl_b32 s58, s58, 13
  s_add_u32 s58, s58, s13
  buffer_load_dwordx4 v9, s[68:71], s58 offen lds
  s_add_u32 s58, s67, 14
  s_and_b32 s58, s58, 15
  s_add_u32 m0, s66, 24576
  s_lshl_b32 s58, s58, 13
  s_add_u32 s58, s58, s12
  buffer_load_dwordx4 v9, s[68:71], s58 offen lds
  s_add_u32 s58, s67, 14
  s_and_b32 s58, s58, 15
  s_add_u32 m0, s66, 25600
  s_lshl_b32 s58, s58, 13
  s_add_u32 s58, s58, s13
  buffer_load_dwordx4 v9, s[68:71], s58 offen lds
  s_add_u32 s58, s67, 15
  s_and_b32 s58, s58, 15
  s_add_u32 m0, s66, 26624
  s_lshl_b32 s58, s58, 13
  s_add_u32 s58, s58, s12
  buffer_load_dwordx4 v9, s[68:71], s58 offen lds
  s_waitcnt vmcnt(17)
  ds_read_b64_tr_b16 v[184:185], v12 offset:36864
  ds_read_b64_tr_b16 v[188:189], v13 offset:36864
  s_waitcnt lgkmcnt(0)
  s_add_u32 s58, s67, 15
  s_and_b32 s58, s58, 15
  s_add_u32 m0, s66, 36864
  s_lshl_b32 s58, s58, 13
  s_add_u32 s58, s58, s13
  buffer_load_dwordx4 v9, s[68:71], s58 offen lds
  s_mov_b32 s72, s40
  s_and_b32 s73, s41, 0xffff
  s_mov_b32 s74, 16777216
  s_mov_b32 s75, 0x20000
  v_lshrrev_b32 v4, 5, v2
  s_lshl_b32 s56, s46, 15
  s_lshl_b32 s57, s52, 13
  s_add_u32 s56, s56, s57
  s_add_u32 s56, s56, 65536
  v_lshl_add_u32 v3, v2, 4, s56
  v_and_b32 v5, 15, v2
  v_lshlrev_b32 v6, 4, v5
  v_lshl_add_u32 v6, v4, 8, v6
  v_bfe_u32 v7, v2, 4, 1
  v_lshl_add_u32 v6, v7, 10, v6
  s_lshl_b32 s56, s52, 14
  s_add_u32 s56, s56, 2162688
  v_add_u32 v6, s56, v6
  s_lshr_b32 s58, s67, 2
  v_lshrrev_b32 v7, 3, v5
  v_bfe_u32 v8, v2, 1, 1
  v_lshl_add_u32 v7, v7, 1, v8
  v_add_u32 v7, s58, v7
  v_and_b32 v7, 3, v7
  v_lshlrev_b32 v7, 12, v7
  v_and_b32 v8, 1, v2
  v_lshl_add_u32 v7, v8, 6, v7
  v_lshl_add_u32 v7, v4, 4, v7
  s_add_u32 s56, s56, 2048
  v_add_u32 v5, s56, v7
  s_add_u32 s56, s58, 0
  s_and_b32 s56, s56, 3
  s_lshl_b32 s4, s56, 12
  s_lshl_b32 s8, s56, 11
  s_add_u32 s56, s58, 1
  s_and_b32 s56, s56, 3
  s_lshl_b32 s5, s56, 12
  s_lshl_b32 s9, s56, 11
  s_add_u32 s56, s58, 2
  s_and_b32 s56, s56, 3
  s_lshl_b32 s6, s56, 12
  s_lshl_b32 s10, s56, 11
  s_add_u32 s56, s58, 3
  s_and_b32 s56, s56, 3
  s_lshl_b32 s7, s56, 12
  s_lshl_b32 s11, s56, 11
  s_waitcnt vmcnt(15)
  ds_read_b64_tr_b16 v[178:179], v12 offset:37888
  ds_read_b64_tr_b16 v[182:183], v13 offset:37888
  ds_read_b64_tr_b16 v[186:187], v12 offset:38912
  ds_read_b64_tr_b16 v[190:191], v13 offset:38912
  ds_read_b64_tr_b16 v[192:193], v14 offset:8192
  ds_read_b64_tr_b16 v[196:197], v15 offset:8192
  s_waitcnt vmcnt(12)
  ds_read_b64_tr_b16 v[200:201], v14 offset:9216
  ds_read_b64_tr_b16 v[204:205], v15 offset:9216
  ds_read_b64_tr_b16 v[194:195], v14 offset:16384
  ds_read_b64_tr_b16 v[198:199], v15 offset:16384
  ds_read_b64_tr_b16 v[202:203], v14 offset:17408
  ds_read_b64_tr_b16 v[206:207], v15 offset:17408
  s_waitcnt lgkmcnt(0)
  s_cmp_lg_u32 s52, 0
  s_cbranch_scc1 LA_go
  s_and_b32 s58, s2, 7
  s_mul_i32 s58, s58, 4352
  s_add_u32 s58, s58, 2293760
  v_and_b32 v9, 7, v2
  v_lshl_add_u32 v9, v9, 2, s58
  v_bfe_u32 v7, v2, 3, 0
  v_mul_u32_u24 v7, 34816, v7
  v_add_u32 v9, v9, v7
  s_mov_b32 s58, 0
LA_poll:
  global_load_dword v7, v9, s[40:41] sc1
  s_add_u32 s58, s58, 1
  s_cmp_gt_u32 s58, 262144
  s_cbranch_scc1 LA_go
  s_waitcnt vmcnt(0)
  v_cmp_eq_u32 vcc, 0, v7
  s_lshr_b32 s57, vcc_lo, 16
  s_and_b32 s57, s57, vcc_lo
  s_lshr_b32 s56, s57, 8
  s_and_b32 s57, s57, s56
  s_and_b32 s57, s57, 0xff
  s_cbranch_scc1 LA_poll
LA_go:
  s_barrier
  buffer_load_dwordx4 v[48:51], v5, s[72:75], 0 offen offset:0
  buffer_load_dwordx4 v[52:55], v5, s[72:75], 0 offen offset:32
  buffer_load_dwordx4 v[72:75], v6, s[72:75], s4 offen offset:0
  buffer_load_dwordx4 v[76:79], v6, s[72:75], s4 offen offset:512
  buffer_load_dwordx4 v[64:67], v3, s[72:75], s8 offen offset:0
  buffer_load_dwordx4 v[68:71], v3, s[72:75], s8 offen offset:1024
  buffer_load_dwordx4 v[232:235], v6, s[72:75], s5 offen offset:0
  buffer_load_dwordx4 v[236:239], v6, s[72:75], s5 offen offset:512
  buffer_load_dwordx4 v[208:211], v3, s[72:75], s9 offen offset:0
  buffer_load_dwordx4 v[212:215], v3, s[72:75], s9 offen offset:1024
  s_mov_b32 s56, 0x358637bd
  s_waitcnt vmcnt(8)
  v_cvt_pk_bf16_f32 v112, v48, v49
  v_cvt_pk_bf16_f32 v113, v50, v51
  v_cvt_pk_bf16_f32 v114, v52, v53
  v_cvt_pk_bf16_f32 v115, v54, v55
  buffer_load_dwordx4 v[240:243], v6, s[72:75], s6 offen offset:0
  buffer_load_dwordx4 v[244:247], v6, s[72:75], s6 offen offset:512
  s_waitcnt vmcnt(8)
  v_cvt_pk_bf16_f32 v72, v72, v73
  v_cvt_pk_bf16_f32 v73, v74, v75
  v_cvt_pk_bf16_f32 v74, v76, v77
  v_cvt_pk_bf16_f32 v75, v78, v79
  v_mov_b32 v116, v112
  v_mov_b32 v117, v113
  v_mov_b32 v118, v114
  v_mov_b32 v119, v115
  v_permlane16_swap_b32 v72, v116
  v_permlane16_swap_b32 v73, v117
  v_permlane16_swap_b32 v74, v118
  v_permlane16_swap_b32 v75, v119
  buffer_load_dwordx4 v[216:219], v3, s[72:75], s10 offen offset:0
  s_waitcnt vmcnt(8)
  v_mfma_f32_32x32x16_bf16 v[80:95], v[72:75], v[64:67], 0
  buffer_load_dwordx4 v[220:223], v3, s[72:75], s10 offen offset:1024
  s_waitcnt vmcnt(8)
  v_mfma_f32_32x32x16_bf16 v[96:111], v[116:119], v[68:71], 0
  buffer_load_dwordx4 v[248:251], v6, s[72:75], s7 offen offset:0
  buffer_load_dwordx4 v[252:255], v6, s[72:75], s7 offen offset:512
  s_waitcnt vmcnt(8)
  v_cvt_pk_bf16_f32 v232, v232, v233
  v_cvt_pk_bf16_f32 v233, v234, v235
  v_cvt_pk_bf16_f32 v234, v236, v237
  v_cvt_pk_bf16_f32 v235, v238, v239
  v_mov_b32 v120, v112
  v_mov_b32 v121, v113
  v_mov_b32 v122, v114
  v_mov_b32 v123, v115
  v_permlane16_swap_b32 v232, v120
  v_permlane16_swap_b32 v233, v121
  v_permlane16_swap_b32 v234, v122
  v_permlane16_swap_b32 v235, v123
  buffer_load_dwordx4 v[224:227], v3, s[72:75], s11 offen offset:0
  buffer_load_dwordx4 v[228:231], v3, s[72:75], s11 offen offset:1024
  v_add_f32 v88, s56, v88
  v_rcp_f32 v88, v88
  s_nop 0
  v_pk_mul_f32 v[80:81], v[80:81], v[88:89] op_sel_hi:[1,0]
  v_pk_mul_f32 v[82:83], v[82:83], v[88:89] op_sel_hi:[1,0]
  v_pk_mul_f32 v[84:85], v[84:85], v[88:89] op_sel_hi:[1,0]
  v_pk_mul_f32 v[86:87], v[86:87], v[88:89] op_sel_hi:[1,0]
  v_cvt_pk_bf16_f32 v124, v80, v81
  v_cvt_pk_bf16_f32 v125, v82, v83
  v_cvt_pk_bf16_f32 v126, v84, v85
  v_cvt_pk_bf16_f32 v127, v86, v87
  s_waitcnt vmcnt(9)
  v_mfma_f32_32x32x16_bf16 v[80:95], v[232:235], v[208:211], 0
  v_add_f32 v105, s56, v105
  v_rcp_f32 v104, v105
  s_nop 0
  v_mfma_f32_32x32x16_bf16 v[32:47], v[132:135], v[124:127], 0
  v_pk_mul_f32 v[96:97], v[96:97], v[104:105] op_sel_hi:[1,0]
  v_pk_mul_f32 v[98:99], v[98:99], v[104:105] op_sel_hi:[1,0]
  v_pk_mul_f32 v[100:101], v[100:101], v[104:105] op_sel_hi:[1,0]
  v_mfma_f32_32x32x16_bf16 v[48:63], v[136:139], v[124:127], 0
  v_pk_mul_f32 v[102:103], v[102:103], v[104:105] op_sel_hi:[1,0]
  v_cvt_pk_bf16_f32 v8, v96, v97
  v_cvt_pk_bf16_f32 v9, v98, v99
  v_mfma_f32_32x32x16_bf16 v[64:79], v[140:143], v[124:127], 0
  v_cvt_pk_bf16_f32 v10, v100, v101
  v_cvt_pk_bf16_f32 v11, v102, v103
  v_mfma_f32_32x32x16_bf16 v[16:31], v[128:131], v[124:127], 0
  s_waitcnt vmcnt(8)
  v_mfma_f32_32x32x16_bf16 v[96:111], v[120:123], v[212:215], 0
  v_add_f32 v90, s56, v90
  v_rcp_f32 v90, v90
  s_nop 0
  v_pk_mul_f32 v[80:81], v[80:81], v[90:91] op_sel_hi:[1,0]
  v_pk_mul_f32 v[82:83], v[82:83], v[90:91] op_sel_hi:[1,0]
  v_pk_mul_f32 v[84:85], v[84:85], v[90:91] op_sel_hi:[1,0]
  v_pk_mul_f32 v[86:87], v[86:87], v[90:91] op_sel_hi:[1,0]
  v_mfma_f32_32x32x16_bf16 v[32:47], v[148:151], v[8:11], v[32:47]
  v_cvt_pk_bf16_f32 v124, v80, v81
  v_cvt_pk_bf16_f32 v125, v82, v83
  v_cvt_pk_bf16_f32 v126, v84, v85
  v_cvt_pk_bf16_f32 v127, v86, v87
  s_waitcnt vmcnt(6)
  v_cvt_pk_bf16_f32 v240, v240, v241
  v_cvt_pk_bf16_f32 v241, v242, v243
  v_mfma_f32_32x32x16_bf16 v[48:63], v[152:155], v[8:11], v[48:63]
  v_cvt_pk_bf16_f32 v242, v244, v245
  v_cvt_pk_bf16_f32 v243, v246, v247
  v_mov_b32 v116, v112
  v_mov_b32 v117, v113
  v_mov_b32 v118, v114
  v_mov_b32 v119, v115
  v_permlane16_swap_b32 v240, v116
  v_mfma_f32_32x32x16_bf16 v[64:79], v[156:159], v[8:11], v[64:79]
  v_permlane16_swap_b32 v241, v117
  v_permlane16_swap_b32 v242, v118
  v_permlane16_swap_b32 v243, v119
  ds_read_b64_tr_b16 v[128:129], v12 offset:0
  ds_read_b64_tr_b16 v[132:133], v13 offset:0
  ds_read_b64_tr_b16 v[136:137], v12 offset:1024
  ds_read_b64_tr_b16 v[140:141], v13 offset:1024
  v_mfma_f32_32x32x16_bf16 v[16:31], v[144:147], v[8:11], v[16:31]
  ds_read_b64_tr_b16 v[130:131], v12 offset:2048
  ds_read_b64_tr_b16 v[134:135], v13 offset:2048
  ds_read_b64_tr_b16 v[138:139], v12 offset:12288
  ds_read_b64_tr_b16 v[142:143], v13 offset:12288
  s_waitcnt vmcnt(5)
  v_mfma_f32_32x32x16_bf16 v[80:95], v[240:243], v[216:219], 0
  v_add_f32 v107, s56, v107
  v_rcp_f32 v106, v107
  s_nop 0
  v_pk_mul_f32 v[96:97], v[96:97], v[106:107] op_sel_hi:[1,0]
  v_mfma_f32_32x32x16_bf16 v[32:47], v[164:167], v[124:127], v[32:47]
  v_pk_mul_f32 v[98:99], v[98:99], v[106:107] op_sel_hi:[1,0]
  v_pk_mul_f32 v[100:101], v[100:101], v[106:107] op_sel_hi:[1,0]
  v_pk_mul_f32 v[102:103], v[102:103], v[106:107] op_sel_hi:[1,0]
  v_cvt_pk_bf16_f32 v212, v96, v97
  v_mfma_f32_32x32x16_bf16 v[48:63], v[168:171], v[124:127], v[48:63]
  v_cvt_pk_bf16_f32 v213, v98, v99
  v_cvt_pk_bf16_f32 v214, v100, v101
  v_cvt_pk_bf16_f32 v215, v102, v103
  ds_read_b64_tr_b16 v[144:145], v12 offset:13312
  v_mfma_f32_32x32x16_bf16 v[64:79], v[172:175], v[124:127], v[64:79]
  ds_read_b64_tr_b16 v[148:149], v13 offset:13312
  ds_read_b64_tr_b16 v[152:153], v12 offset:14336
  ds_read_b64_tr_b16 v[156:157], v13 offset:14336
  ds_read_b64_tr_b16 v[146:147], v14 offset:0
  v_mfma_f32_32x32x16_bf16 v[16:31], v[160:163], v[124:127], v[16:31]
  ds_read_b64_tr_b16 v[150:151], v15 offset:0
  ds_read_b64_tr_b16 v[154:155], v14 offset:1024
  ds_read_b64_tr_b16 v[158:159], v15 offset:1024
  s_waitcnt vmcnt(4)
  v_mfma_f32_32x32x16_bf16 v[96:111], v[116:119], v[220:223], 0
  v_add_f32 v92, s56, v92
  v_rcp_f32 v92, v92
  s_nop 0
  v_pk_mul_f32 v[80:81], v[80:81], v[92:93] op_sel_hi:[1,0]
  v_pk_mul_f32 v[82:83], v[82:83], v[92:93] op_sel_hi:[1,0]
  v_pk_mul_f32 v[84:85], v[84:85], v[92:93] op_sel_hi:[1,0]
  v_pk_mul_f32 v[86:87], v[86:87], v[92:93] op_sel_hi:[1,0]
  v_cvt_pk_bf16_f32 v216, v80, v81
  v_mfma_f32_32x32x16_bf16 v[32:47], v[180:183], v[212:215], v[32:47]
  v_cvt_pk_bf16_f32 v217, v82, v83
  v_cvt_pk_bf16_f32 v218, v84, v85
  v_cvt_pk_bf16_f32 v219, v86, v87
  s_waitcnt vmcnt(2)
  v_cvt_pk_bf16_f32 v248, v248, v249
  v_cvt_pk_bf16_f32 v249, v250, v251
  v_cvt_pk_bf16_f32 v250, v252, v253
  v_cvt_pk_bf16_f32 v251, v254, v255
  v_mfma_f32_32x32x16_bf16 v[48:63], v[184:187], v[212:215], v[48:63]
  v_mov_b32 v120, v112
  v_mov_b32 v121, v113
  v_mov_b32 v122, v114
  v_mov_b32 v123, v115
  v_permlane16_swap_b32 v248, v120
  v_permlane16_swap_b32 v249, v121
  v_permlane16_swap_b32 v250, v122
  v_permlane16_swap_b32 v251, v123
  v_mfma_f32_32x32x16_bf16 v[64:79], v[188:191], v[212:215], v[64:79]
  ds_read_b64_tr_b16 v[160:161], v12 offset:24576
  ds_read_b64_tr_b16 v[164:165], v13 offset:24576
  ds_read_b64_tr_b16 v[168:169], v12 offset:25600
  ds_read_b64_tr_b16 v[172:173], v13 offset:25600
  ds_read_b64_tr_b16 v[162:163], v12 offset:26624
  ds_read_b64_tr_b16 v[166:167], v13 offset:26624
  ds_read_b64_tr_b16 v[170:171], v12 offset:36864
  ds_read_b64_tr_b16 v[174:175], v13 offset:36864
  s_waitcnt vmcnt(1)
  v_mfma_f32_32x32x16_bf16 v[80:95], v[248:251], v[224:227], 0
  v_add_f32 v109, s56, v109
  v_rcp_f32 v108, v109
  s_nop 0
  v_mfma_f32_32x32x16_bf16 v[32:47], v[196:199], v[216:219], v[32:47]
  v_pk_mul_f32 v[96:97], v[96:97], v[108:109] op_sel_hi:[1,0]
  v_pk_mul_f32 v[98:99], v[98:99], v[108:109] op_sel_hi:[1,0]
  v_pk_mul_f32 v[100:101], v[100:101], v[108:109] op_sel_hi:[1,0]
  v_mfma_f32_32x32x16_bf16 v[48:63], v[200:203], v[216:219], v[48:63]
  v_pk_mul_f32 v[102:103], v[102:103], v[108:109] op_sel_hi:[1,0]
  v_cvt_pk_bf16_f32 v220, v96, v97
  v_cvt_pk_bf16_f32 v221, v98, v99
  v_mfma_f32_32x32x16_bf16 v[64:79], v[204:207], v[216:219], v[64:79]
  v_cvt_pk_bf16_f32 v222, v100, v101
  v_cvt_pk_bf16_f32 v223, v102, v103
  s_waitcnt vmcnt(0)
  s_waitcnt lgkmcnt(15)
  v_mfma_f32_32x32x16_bf16 v[96:111], v[120:123], v[228:231], 0
  v_add_f32 v94, s56, v94
  v_rcp_f32 v94, v94
  s_nop 0
  v_pk_mul_f32 v[80:81], v[80:81], v[94:95] op_sel_hi:[1,0]
  v_mfma_f32_32x32x16_bf16 v[32:47], v[132:135], v[220:223], v[32:47]
  v_pk_mul_f32 v[82:83], v[82:83], v[94:95] op_sel_hi:[1,0]
  v_pk_mul_f32 v[84:85], v[84:85], v[94:95] op_sel_hi:[1,0]
  v_pk_mul_f32 v[86:87], v[86:87], v[94:95] op_sel_hi:[1,0]
  v_cvt_pk_bf16_f32 v224, v80, v81
  v_mfma_f32_32x32x16_bf16 v[48:63], v[136:139], v[220:223], v[48:63]
  v_cvt_pk_bf16_f32 v225, v82, v83
  v_cvt_pk_bf16_f32 v226, v84, v85
  v_cvt_pk_bf16_f32 v227, v86, v87
  v_lshl_add_u32 v6, v2, 4, s66
  v_and_b32 v7, 31, v2
  v_mul_u32_u24 v7, 272, v7
  v_lshl_add_u32 v7, v4, 4, v7
  s_lshl_b32 s57, s52, 6
  s_add_u32 s57, s57, 49152
  v_add_u32 v7, s57, v7
  v_lshrrev_b32 v5, 4, v0
  v_and_b32 v4, 15, v0
  v_mul_u32_u24 v3, 272, v5
  v_lshl_add_u32 v3, v4, 4, v3
  v_add_u32 v3, 49152, v3
  s_lshl_b32 s58, s46, 16
  s_lshl_b32 s57, s47, 8
  s_add_u32 s58, s58, s57
  v_lshlrev_b32 v5, 11, v5
  v_lshl_add_u32 v5, v4, 4, v5
  v_add_u32 v5, s58, v5
  v_add_u32 v4, 0x8000, v5
  v_mfma_f32_32x32x16_bf16 v[64:79], v[140:143], v[220:223], v[64:79]
  s_xor_b32 s58, s52, 1
  s_mul_i32 s58, s58, 3072
  v_lshl_add_u32 v12, v2, 4, s58
  s_xor_b32 s58, s52, 2
  s_mul_i32 s58, s58, 3072
  v_lshl_add_u32 v13, v2, 4, s58
  s_xor_b32 s58, s52, 3
  s_mul_i32 s58, s58, 3072
  v_lshl_add_u32 v14, v2, 4, s58
  s_waitcnt lgkmcnt(8)
  v_mfma_f32_32x32x16_bf16 v[32:47], v[148:151], v[224:227], v[32:47]
  v_add_f32 v111, s56, v111
  v_rcp_f32 v110, v111
  s_nop 0
  v_pk_mul_f32 v[96:97], v[96:97], v[110:111] op_sel_hi:[1,0]
  v_mfma_f32_32x32x16_bf16 v[48:63], v[152:155], v[224:227], v[48:63]
  v_pk_mul_f32 v[98:99], v[98:99], v[110:111] op_sel_hi:[1,0]
  v_pk_mul_f32 v[100:101], v[100:101], v[110:111] op_sel_hi:[1,0]
  v_pk_mul_f32 v[102:103], v[102:103], v[110:111] op_sel_hi:[1,0]
  v_cvt_pk_bf16_f32 v228, v96, v97
  v_mfma_f32_32x32x16_bf16 v[64:79], v[156:159], v[224:227], v[64:79]
  v_cvt_pk_bf16_f32 v229, v98, v99
  v_cvt_pk_bf16_f32 v230, v100, v101
  v_cvt_pk_bf16_f32 v231, v102, v103
  s_waitcnt lgkmcnt(0)
  s_nop 0
  v_mfma_f32_32x32x16_bf16 v[32:47], v[164:167], v[228:231], v[32:47]
  v_mfma_f32_32x32x16_bf16 v[48:63], v[168:171], v[228:231], v[48:63]
  v_mfma_f32_32x32x16_bf16 v[64:79], v[172:175], v[228:231], v[64:79]
  v_mfma_f32_32x32x16_bf16 v[16:31], v[176:179], v[212:215], v[16:31]
  v_mfma_f32_32x32x16_bf16 v[16:31], v[192:195], v[216:219], v[16:31]
  v_mfma_f32_32x32x16_bf16 v[16:31], v[128:131], v[220:223], v[16:31]
  s_nop 6
  ds_write_b128 v6, v[32:35] offset:0
  ds_write_b128 v6, v[36:39] offset:1024
  ds_write_b128 v6, v[40:43] offset:2048
  ds_write_b128 v6, v[44:47] offset:12288
  v_mfma_f32_32x32x16_bf16 v[16:31], v[144:147], v[224:227], v[16:31]
  ds_write_b128 v6, v[48:51] offset:13312
  ds_write_b128 v6, v[52:55] offset:14336
  ds_write_b128 v6, v[56:59] offset:24576
  ds_write_b128 v6, v[60:63] offset:25600
  v_mfma_f32_32x32x16_bf16 v[16:31], v[160:163], v[228:231], v[16:31]
  ds_write_b128 v6, v[64:67] offset:26624
  ds_write_b128 v6, v[68:71] offset:36864
  ds_write_b128 v6, v[72:75] offset:37888
  ds_write_b128 v6, v[76:79] offset:38912
  s_waitcnt lgkmcnt(0)
  s_barrier
  ds_read_b128 v[32:35], v12 offset:0
  ds_read_b128 v[48:51], v13 offset:13312
  ds_read_b128 v[64:67], v14 offset:26624
  ds_read_b128 v[36:39], v12 offset:1024
  ds_read_b128 v[52:55], v13 offset:14336
  ds_read_b128 v[68:71], v14 offset:36864
  ds_read_b128 v[40:43], v12 offset:2048
  ds_read_b128 v[56:59], v13 offset:24576
  ds_read_b128 v[72:75], v14 offset:37888
  ds_read_b128 v[44:47], v12 offset:12288
  ds_read_b128 v[60:63], v13 offset:25600
  ds_read_b128 v[76:79], v14 offset:38912
  s_waitcnt lgkmcnt(9)
  v_pk_add_f32 v[16:17], v[16:17], v[32:33]
  v_pk_add_f32 v[48:49], v[48:49], v[64:65]
  v_pk_add_f32 v[18:19], v[18:19], v[34:35]
  v_pk_add_f32 v[50:51], v[50:51], v[66:67]
  v_pk_add_f32 v[16:17], v[16:17], v[48:49]
  v_pk_add_f32 v[18:19], v[18:19], v[50:51]
  s_waitcnt lgkmcnt(6)
  v_pk_add_f32 v[20:21], v[20:21], v[36:37]
  v_pk_add_f32 v[52:53], v[52:53], v[68:69]
  v_pk_add_f32 v[22:23], v[22:23], v[38:39]
  v_pk_add_f32 v[54:55], v[54:55], v[70:71]
  v_pk_add_f32 v[20:21], v[20:21], v[52:53]
  v_pk_add_f32 v[22:23], v[22:23], v[54:55]
  v_cvt_pk_bf16_f32 v80, v16, v17
  v_cvt_pk_bf16_f32 v81, v18, v19
  v_cvt_pk_bf16_f32 v82, v20, v21
  v_cvt_pk_bf16_f32 v83, v22, v23
  s_nop 0
  v_permlane32_swap_b32 v80, v82
  v_permlane32_swap_b32 v81, v83
  ds_write_b128 v7, v[80:83] offset:0
  s_waitcnt lgkmcnt(3)
  v_pk_add_f32 v[24:25], v[24:25], v[40:41]
  v_pk_add_f32 v[56:57], v[56:57], v[72:73]
  v_pk_add_f32 v[26:27], v[26:27], v[42:43]
  v_pk_add_f32 v[58:59], v[58:59], v[74:75]
  v_pk_add_f32 v[24:25], v[24:25], v[56:57]
  v_pk_add_f32 v[26:27], v[26:27], v[58:59]
  s_waitcnt lgkmcnt(0)
  v_pk_add_f32 v[28:29], v[28:29], v[44:45]
  v_pk_add_f32 v[60:61], v[60:61], v[76:77]
  v_pk_add_f32 v[30:31], v[30:31], v[46:47]
  v_pk_add_f32 v[62:63], v[62:63], v[78:79]
  v_pk_add_f32 v[28:29], v[28:29], v[60:61]
  v_pk_add_f32 v[30:31], v[30:31], v[62:63]
  v_cvt_pk_bf16_f32 v84, v24, v25
  v_cvt_pk_bf16_f32 v85, v26, v27
  v_cvt_pk_bf16_f32 v86, v28, v29
  v_cvt_pk_bf16_f32 v87, v30, v31
  s_nop 0
  v_permlane32_swap_b32 v84, v86
  v_permlane32_swap_b32 v85, v87
  ds_write_b128 v7, v[84:87] offset:32
  s_waitcnt lgkmcnt(0)
  s_barrier
  ds_read_b128 v[80:83], v3
  ds_read_b128 v[84:87], v3 offset:4352
  s_waitcnt lgkmcnt(1)
  global_store_dwordx4 v5, v[80:83], s[36:37]
  s_waitcnt lgkmcnt(0)
  global_store_dwordx4 v4, v[84:87], s[36:37]
  s_endpgm
L_exit:
  s_endpgm
L_roleB:
  s_sub_u32 s48, s2, 256
  s_and_b32 s53, s48, 7
  s_lshl_b32 s53, s53, 5
  s_lshr_b32 s54, s48, 3
  s_add_u32 s49, s53, s54
  v_lshrrev_b32 v1, 6, v0
  v_and_b32 v2, 63, v0
  v_readfirstlane_b32 s50, v1
  s_nop 0
  s_lshr_b32 s51, s50, 1
  s_and_b32 s52, s50, 1
  s_and_b32 s64, s48, 7
  s_lshr_b32 s67, s48, 3
  s_mov_b32 s57, 0x05040100
  s_mov_b32 s58, 0x07060302
  s_lshl_b32 s54, s64, 2
  v_mov_b32 v19, s54
  v_mov_b32 v18, 0
  v_and_b32 v8, 7, v2
  v_sub_u32 v9, 7, v8
  v_lshrrev_b32 v10, 3, v2
  v_lshlrev_b32 v20, 13, v9
  v_lshl_add_u32 v20, v10, 2, v20
  s_lshl_b32 s54, s67, 16
  s_lshl_b32 s53, s64, 7
  s_add_u32 s54, s54, s53
  s_lshl_b32 s53, s50, 5
  s_add_u32 s54, s54, s53
  v_add_u32 v20, s54, v20
  v_add_u32 v21, 0x1000, v20
  s_mul_i32 s54, s64, 270336
  s_add_u32 s54, s54, 4198400
  v_mul_u32_u24 v23, 4224, v2
  v_add_u32 v23, s54, v23
  s_lshl_b32 s53, s67, 7
  s_sub_u32 s54, s54, s53
  s_mul_i32 s53, s50, 67584
  s_add_u32 s54, s54, s53
  s_add_u32 s54, s54, 1984
  v_mul_u32_u24 v22, 8448, v10
  v_lshl_add_u32 v22, v8, 4, v22
  v_add_u32 v22, s54, v22
  s_lshl_b32 s53, s67, 17
  s_lshl_b32 s54, s64, 7
  s_add_u32 s70, s53, s54
  s_add_u32 s70, s70, 1024
  s_lshl_b32 s53, s50, 15
  s_add_u32 s53, s53, s70
  v_lshlrev_b32 v216, 11, v10
  v_lshl_add_u32 v216, v8, 4, v216
  v_add_u32 v216, s53, v216
  v_add_u32 v217, 0x4000, v216
  s_getreg_b32 s71, hwreg(HW_REG_XCC_ID)
  s_and_b32 s71, s71, 15
  s_mul_i32 s53, s71, s71
  s_lshl_b32 s53, s53, 18
  s_lshl_b32 s71, s71, 8
  s_add_u32 s71, s71, s53
  s_add_u32 s71, s71, 1
  s_lshl_b32 s53, s49, 9
  s_lshl_b32 s54, s50, 7
  s_add_u32 s53, s53, s54
  v_lshl_add_u32 v3, v2, 1, s53
  s_lshl_b32 s53, s64, 9
  s_add_u32 s53, s53, 2228224
  v_mov_b32 v17, s53
  s_lshl_b32 s53, s49, 2
  s_waitcnt lgkmcnt(0)
  s_load_dword s55, s[32:33], s53
  s_load_dword s56, s[34:35], s53
  s_add_u32 s68, s67, 3
  s_sub_u32 s68, s68, s50
  s_cmp_lg_u32 s68, 0
  s_cbranch_scc1 LB_noz
  global_store_dword v17, v18, s[40:41] sc1
  global_store_dword v17, v18, s[40:41] offset:128 sc1
  global_store_dword v17, v18, s[40:41] offset:64 sc1
  global_store_dword v17, v18, s[40:41] offset:256 sc1
  global_store_dword v17, v18, s[40:41] offset:384 sc1
LB_noz:
  global_load_ushort v4, v3, s[24:25]
  global_load_ushort v5, v3, s[26:27]
  global_load_ushort v6, v3, s[28:29]
  global_load_ushort v7, v3, s[30:31]
  s_mov_b32 s4, s22
  s_and_b32 s5, s23, 0xffff
  s_mov_b32 s6, 0x200000
  s_mov_b32 s7, 0x20000
  s_lshl_b32 s54, s67, 16
  s_lshl_b32 s53, s64, 7
  s_add_u32 s54, s54, s53
  s_lshl_b32 s53, s50, 14
  s_add_u32 s54, s54, s53
  s_lshl_b32 s53, s50, 1
  v_xor_b32 v21, s53, v8
  v_lshlrev_b32 v20, 10, v10
  v_lshl_add_u32 v20, v21, 4, v20
  v_xor_b32 v21, 16, v20
  v_add_u32 v21, 0x2000, v21
  s_mul_i32 s53, s51, 9728
  s_lshl_b32 s65, s52, 11
  s_add_u32 s53, s53, s65
  s_add_u32 m0, s53, 16896
  s_nop 0
  buffer_load_dwordx4 v20, s[4:7], s54 offen lds
  s_add_u32 m0, s53, 17920
  s_nop 0
  buffer_load_dwordx4 v21, s[4:7], s54 offen lds
  v_lshrrev_b32 v20, 2, v10
  s_lshl_b32 s53, s50, 1
  v_add_u32 v20, s53, v20
  v_xor_b32 v20, v20, v9
  v_lshlrev_b32 v20, 4, v20
  v_and_b32 v21, 3, v10
  v_lshl_add_u32 v20, v21, 2, v20
  v_and_b32 v21, 3, v9
  v_lshl_add_u32 v20, v21, 10, v20
  v_lshrrev_b32 v21, 2, v9
  v_mul_u32_u24 v21, 9728, v21
  v_add_u32 v20, v20, v21
  v_add_u32 v20, 16896, v20
  v_mov_b32 v10, 0
  v_mov_b32 v11, 0
  v_mov_b32 v12, 0
  v_mov_b32 v13, 0
  s_mul_i32 s53, s51, 9728
  s_mul_i32 s54, s52, 4872
  s_add_u32 s53, s53, s54
  s_add_u32 s53, s53, 20992
  v_lshl_add_u32 v9, v2, 3, s53
  ds_write_b64 v9, v[10:11]
  s_mul_i32 s53, s50, 4224
  v_and_b32 v9, 15, v2
  v_lshl_add_u32 v9, v9, 2, s53
  ds_write_b32 v9, v10
  s_lshl_b32 s53, s51, 13
  s_add_u32 s53, s53, 60416
  s_mul_i32 s54, s51, 8448
  s_add_u32 s54, s54, 64
  v_and_b32 v9, 31, v2
  v_add_u32 v9, 32, v9
  v_lshrrev_b32 v14, 5, v2
  v_mul_u32_u24 v15, 4224, v14
  v_add_u32 v15, s54, v15
  v_lshl_add_u32 v24, v9, 4, s53
  v_cmp_eq_u32 s[60:61], 63, v9
  v_cmp_eq_u32 s[62:63], 0, v2
  v_cmp_ne_u32 vcc, 0, v14
  v_mov_b32 v25, 0x01000100
  v_mov_b32 v26, 0x03020100
  v_cndmask_b32 v40, v25, v26, vcc
  v_mov_b32 v27, 0x01000504
  v_cndmask_b32 v42, v27, v25, vcc
  v_mov_b32 v25, 0x05040302
  v_cndmask_b32 v43, v26, v25, vcc
  v_mov_b32 v26, 0x05040504
  v_cndmask_b32 v41, v25, v26, vcc
  s_cmp_lg_u32 s52, 0
  s_cbranch_scc1 LB_x1
  v_lshl_add_u32 v32, v2, 4, s53
  v_add_u32 v33, -4, v32
  v_lshl_add_u32 v34, v2, 3, s54
  v_add_u32 v35, 3072, v24
  v_add_u32 v36, 3088, v24
  s_add_u32 s53, s53, 3072
  v_mov_b32 v25, s53
  v_cndmask_b32 v36, v36, v25, s[60:61]
  v_lshl_add_u32 v37, v9, 6, v15
  s_branch LB_x2
LB_x1:
  v_add_u32 v32, 1024, v24
  v_lshl_add_u32 v33, v14, 4, v32
  s_add_u32 s54, s53, 2560
  v_mov_b32 v25, s54
  v_cmp_eq_u32 vcc, 63, v2
  s_nop 1
  v_cndmask_b32 v33, v33, v25, vcc
  s_add_u32 s54, s53, 1020
  v_mov_b32 v25, s54
  v_cndmask_b32 v33, v33, v25, s[62:63]
  v_lshl_add_u32 v34, v9, 4, v15
  v_add_u32 v35, 2048, v24
  v_add_u32 v36, 2064, v24
  s_add_u32 s53, s53, 3584
  v_mov_b32 v25, s53
  v_cndmask_b32 v36, v36, v25, s[60:61]
  v_lshl_add_u32 v37, v9, 5, v15
LB_x2:
  s_waitcnt lgkmcnt(0)
  s_lshl_b32 s53, s56, 16
  s_and_b32 s54, s56, 0xffff0000
  s_lshl_b32 s65, s55, 16
  s_and_b32 s66, s55, 0xffff0000
  s_cmp_eq_u32 s51, 0
  s_cselect_b32 s56, s53, s54
  s_cselect_b32 s55, s65, s66
  v_mov_b32 v25, s56
  v_cndmask_b32 v28, 0, v25, s[62:63]
  v_mov_b32 v25, 0x3fb8aa3b
  v_mul_f32 v24, s55, v25
  v_exp_f32 v24, v24
  s_nop 0
  v_cvt_pk_bf16_f32 v24, v24, v24
  v_and_b32 v24, 0xffff0000, v24
  v_and_b32 v29, 15, v2
  v_lshrrev_b32 v30, 4, v2
  v_cvt_f32_u32 v64, v29
  v_mov_b32 v65, 0
  s_mul_i32 s53, s50, 576
  s_add_u32 s53, s53, 36352
  v_mul_u32_u24 v31, 144, v30
  v_add_u32 v31, s53, v31
  v_lshlrev_b32 v9, 3, v2
  v_lshl_add_u32 v9, v30, 4, v9
  v_add_u32 v9, s53, v9
  s_lshl_b32 s53, s50, 8
  s_add_u32 s53, s53, 59392
  v_lshl_add_u32 v14, v2, 2, s53
  v_lshl_add_u32 v15, v30, 6, s53
  v_and_b32 v16, 1, v30
  v_lshlrev_b32 v16, 1, v16
  v_xor_b32 v16, v16, v2
  v_lshlrev_b32 v16, 4, v16
  s_mul_i32 s53, s49, 8448
  s_add_u32 s53, s53, 4194304
  v_add_u32 v16, s53, v16
  s_mov_b32 s44, s40
  s_and_b32 s45, s41, 0xffff
  s_mov_b32 s46, 0x1000000
  s_mov_b32 s47, 0x20000
  v_lshrrev_b32 v44, 2, v29
  v_max_u32 v44, 1, v44
  v_add_u32 v44, 1, v44
  v_mul_u32_u24 v44, 2304, v44
  v_add_u32 v44, v44, v31
  v_lshrrev_b32 v45, 1, v29
  v_min_u32 v45, 4, v45
  v_add_u32 v45, 5, v45
  v_mul_u32_u24 v45, 2304, v45
  v_add_u32 v45, v45, v31
  v_cmp_gt_u32 s[74:75], 8, v29
  s_lshl_b32 s53, s50, 12
  s_add_u32 s53, s53, 60416
  v_lshlrev_b32 v46, 6, v29
  v_lshl_add_u32 v46, v30, 4, v46
  v_add_u32 v46, s53, v46
  v_lshl_add_u32 v47, v29, 1, v30
  v_lshlrev_b32 v47, 4, v47
  v_add_u32 v47, 1536, v47
  v_lshl_add_u32 v48, v30, 4, v29
  v_lshlrev_b32 v48, 4, v48
  v_add_u32 v48, 2048, v48
  v_cmp_gt_u32 vcc, 2, v30
  s_nop 1
  v_cndmask_b32 v47, v48, v47, vcc
  v_add_u32 v47, s53, v47
  v_lshlrev_b32 v48, 8, v30
  v_lshl_add_u32 v48, v29, 3, v48
  s_add_u32 s53, s53, 3072
  v_add_u32 v48, s53, v48
  v_add_u32 v48, 512, v48
  v_lshlrev_b32 v49, 3, v2
  v_add_u32 v49, 76800, v49
  v_cndmask_b32 v48, v49, v48, vcc
  v_mov_b32 v49, s53
  v_cmp_eq_u32 vcc, 32, v2
  s_nop 1
  v_cndmask_b32 v48, v48, v49, vcc
  s_waitcnt vmcnt(2)
  s_cmp_lg_u32 s68, 0
  s_cbranch_scc1 LB_nof
  v_mov_b32 v18, 1
  s_mov_b64 exec, 1
  global_store_dword v19, v18, s[38:39] offset:32 sc1
  s_mov_b64 exec, -1
LB_nof:
  v_lshlrev_b32 v4, 16, v4
  v_lshlrev_b32 v5, 16, v5
  v_lshlrev_b32 v6, 16, v6
  v_lshlrev_b32 v7, 16, v7
  v_mul_f32 v4, v4, v25
  v_exp_f32 v4, v4
  v_mul_f32 v5, v5, v24
  v_mul_f32 v6, v6, v24
  v_cvt_pk_bf16_f32 v4, v4, v4
  v_mul_f32 v7, v7, v24
  v_and_b32 v4, 0xffff0000, v4
  v_mul_f32 v5, 0x3e22f983, v5
  v_mul_f32 v4, v4, v24
  v_add_f32 v6, v6, v6
  v_mul_f32 v4, 0xbfb8aa3b, v4
  v_add_f32 v7, v7, v7
  ds_write_b64 v9, v[4:5]
  ds_write_b64 v9, v[6:7] offset:2304
  v_mul_f32 v26, 0x43700000, v4
  v_mul_f32 v27, 0x43700000, v5
  v_exp_f32 v26, v26
  v_fract_f32 v27, v27
  v_cos_f32 v66, v27
  v_sin_f32 v67, v27
  s_nop 0
  v_mul_f32 v66, v66, v26
  v_mul_f32 v67, v67, v26
  v_mul_f32 v26, 0x43800000, v4
  v_mul_f32 v27, 0x43800000, v5
  v_exp_f32 v26, v26
  v_fract_f32 v27, v27
  v_cos_f32 v68, v27
  v_sin_f32 v69, v27
  s_nop 0
  v_mul_f32 v68, v68, v26
  v_mul_f32 v69, v69, v26
  v_mul_f32 v26, 0x44800000, v4
  v_mul_f32 v27, 0x44800000, v5
  v_exp_f32 v26, v26
  v_fract_f32 v27, v27
  v_cos_f32 v70, v27
  v_sin_f32 v71, v27
  s_nop 0
  v_mul_f32 v70, v70, v26
  v_mul_f32 v71, v71, v26
  v_mul_f32 v72, v6, v68
  v_mul_f32 v73, v6, v69
  v_fma_f32 v72, -v7, v69, v72
  v_fmac_f32 v73, v7, v68
  ds_write_b64 v9, v[72:73] offset:4608
  v_mul_f32 v74, v6, v66
  v_mul_f32 v75, v6, v67
  v_fma_f32 v74, -v7, v67, v74
  v_fmac_f32 v75, v7, v66
  v_mul_f32 v76, v6, v70
  v_mul_f32 v77, v6, v71
  v_fma_f32 v76, -v7, v71, v76
  v_fmac_f32 v77, v7, v70
  ds_write_b64 v9, v[76:77] offset:11520
  v_mul_f32 v78, v74, v66
  v_mul_f32 v79, v74, v67
  v_fma_f32 v78, -v75, v67, v78
  v_fmac_f32 v79, v75, v66
  ds_write_b64 v9, v[78:79] offset:6912
  v_mul_f32 v80, v76, v66
  v_mul_f32 v81, v76, v67
  v_fma_f32 v80, -v77, v67, v80
  v_fmac_f32 v81, v77, v66
  ds_write_b64 v9, v[80:81] offset:13824
  v_mul_f32 v82, v78, v66
  v_mul_f32 v83, v78, v67
  v_fma_f32 v82, -v79, v67, v82
  v_fmac_f32 v83, v79, v66
  ds_write_b64 v9, v[82:83] offset:9216
  v_mul_f32 v84, v80, v66
  v_mul_f32 v85, v80, v67
  v_fma_f32 v84, -v81, v67, v84
  v_fmac_f32 v85, v81, v66
  ds_write_b64 v9, v[84:85] offset:16128
  v_mul_f32 v86, v84, v66
  v_mul_f32 v87, v84, v67
  v_fma_f32 v86, -v85, v67, v86
  v_fmac_f32 v87, v85, v66
  ds_write_b64 v9, v[86:87] offset:18432
  v_mul_f32 v88, v86, v66
  v_mul_f32 v89, v86, v67
  v_fma_f32 v88, -v87, v67, v88
  v_fmac_f32 v89, v87, v66
  ds_write_b64 v9, v[88:89] offset:20736
  s_waitcnt lgkmcnt(0)
  ds_read_b128 v[66:69], v31
  ds_read_b128 v[70:73], v31 offset:16
  s_mov_b32 s69, 0
  v_mov_b32 v208, -1
  v_mov_b32 v209, -1
  v_mov_b32 v210, -1
  v_mov_b32 v211, -1
  s_waitcnt vmcnt(0)
  s_barrier
  ds_read2_b32 v[160:161], v20 offset0:0 offset1:32
  ds_read2_b32 v[162:163], v20 offset0:64 offset1:96
  ds_read2_b32 v[164:165], v20 offset0:128 offset1:160
  ds_read2_b32 v[166:167], v20 offset0:192 offset1:224
  s_waitcnt lgkmcnt(0)
  v_perm_b32 v192, v166, v167, s57
  v_perm_b32 v193, v164, v165, s57
  v_perm_b32 v194, v162, v163, s57
  v_perm_b32 v195, v160, v161, s57
  global_store_dwordx4 v22, v[192:195], s[40:41] offset:-2112 sc1
  global_store_dwordx4 v216, v[208:211], s[36:37] sc1
  v_perm_b32 v196, v166, v167, s58
  v_perm_b32 v197, v164, v165, s58
  v_perm_b32 v198, v162, v163, s58
  v_perm_b32 v199, v160, v161, s58
  global_store_dwordx4 v22, v[196:199], s[40:41] offset:2112 sc1
  global_store_dwordx4 v217, v[208:211], s[36:37] sc1
  s_cmp_lg_u32 s50, 0
  s_cbranch_scc1 LB_k0
  global_load_dword v18, v19, s[38:39] offset:32 sc1
LB_k0:
  s_cmp_lg_u32 s68, 0
  s_cbranch_scc1 LB_h1st
  v_mov_b32 v212, 0
  v_mov_b32 v213, 0
  v_mov_b32 v214, 0
  v_mov_b32 v215, 0
  global_store_dwordx4 v23, v[212:215], s[40:41] sc1
LB_h1st:
  ds_read_b128 v[74:77], v31 offset:2304
  ds_read_b128 v[78:81], v31 offset:2320
  ds_read_b128 v[98:101], v44 offset:0
  ds_read_b128 v[102:105], v44 offset:16
  ds_read_b128 v[106:109], v45 offset:0
  ds_read_b128 v[110:113], v45 offset:16
  s_waitcnt lgkmcnt(6)
  v_mul_f32 v90, v66, v64
  v_mul_f32 v91, v67, v64
  v_mul_f32 v92, v68, v64
  v_mul_f32 v93, v69, v64
  v_mul_f32 v94, v70, v64
  v_mul_f32 v95, v71, v64
  v_mul_f32 v96, v72, v64
  v_mul_f32 v97, v73, v64
  ds_read_b128 v[66:69], v31 offset:32
  ds_read_b128 v[70:73], v31 offset:48
  v_fract_f32 v91, v91
  v_fract_f32 v93, v93
  v_fract_f32 v95, v95
  v_fract_f32 v97, v97
  v_exp_f32 v90, v90
  v_exp_f32 v92, v92
  v_exp_f32 v94, v94
  v_exp_f32 v96, v96
  v_cos_f32 v82, v91
  v_cos_f32 v84, v93
  v_cos_f32 v86, v95
  v_cos_f32 v88, v97
  v_sin_f32 v83, v91
  v_sin_f32 v85, v93
  v_sin_f32 v87, v95
  v_sin_f32 v89, v97
  s_nop 1
  v_mul_f32 v82, v82, v90
  v_mul_f32 v83, v83, v90
  v_mul_f32 v84, v84, v92
  v_mul_f32 v85, v85, v92
  v_mul_f32 v86, v86, v94
  v_mul_f32 v87, v87, v94
  v_mul_f32 v88, v88, v96
  v_mul_f32 v89, v89, v96
  s_waitcnt lgkmcnt(2)
  v_mul_f32 v90, v74, v82
  v_mul_f32 v92, v76, v84
  v_mul_f32 v94, v78, v86
  v_mul_f32 v96, v80, v88
  v_mul_f32 v91, v74, v83
  v_mul_f32 v93, v76, v85
  v_mul_f32 v95, v78, v87
  v_mul_f32 v97, v80, v89
  v_fma_f32 v90, -v75, v83, v90
  v_fma_f32 v92, -v77, v85, v92
  v_fma_f32 v94, -v79, v87, v94
  v_fma_f32 v96, -v81, v89, v96
  v_fmac_f32 v91, v75, v82
  v_fmac_f32 v93, v77, v84
  v_fmac_f32 v95, v79, v86
  v_fmac_f32 v97, v81, v88
  v_cvt_pk_bf16_f32 v122, v90, v91
  v_cvt_pk_bf16_f32 v123, v92, v93
  v_cvt_pk_bf16_f32 v124, v94, v95
  v_cvt_pk_bf16_f32 v125, v96, v97
  v_mul_f32 v90, v83, v83
  v_mul_f32 v92, v85, v85
  v_mul_f32 v94, v87, v87
  v_mul_f32 v96, v89, v89
  v_mul_f32 v83, v82, v83 mul:2
  v_mul_f32 v85, v84, v85 mul:2
  v_mul_f32 v87, v86, v87 mul:2
  v_mul_f32 v89, v88, v89 mul:2
  v_fma_f32 v82, v82, v82, -v90
  v_fma_f32 v84, v84, v84, -v92
  v_fma_f32 v86, v86, v86, -v94
  v_fma_f32 v88, v88, v88, -v96
  v_mul_f32 v90, v83, v83
  v_mul_f32 v92, v85, v85
  v_mul_f32 v94, v87, v87
  v_mul_f32 v96, v89, v89
  v_mul_f32 v115, v82, v83 mul:2
  v_mul_f32 v117, v84, v85 mul:2
  v_mul_f32 v119, v86, v87 mul:2
  v_mul_f32 v121, v88, v89 mul:2
  v_fma_f32 v114, v82, v82, -v90
  v_fma_f32 v116, v84, v84, -v92
  v_fma_f32 v118, v86, v86, -v94
  v_fma_f32 v120, v88, v88, -v96
  v_cndmask_b32 v82, v114, v82, s[74:75]
  v_cndmask_b32 v83, v115, v83, s[74:75]
  v_cndmask_b32 v84, v116, v84, s[74:75]
  v_cndmask_b32 v85, v117, v85, s[74:75]
  v_cndmask_b32 v86, v118, v86, s[74:75]
  v_cndmask_b32 v87, v119, v87, s[74:75]
  v_cndmask_b32 v88, v120, v88, s[74:75]
  v_cndmask_b32 v89, v121, v89, s[74:75]
  v_mul_f32 v90, v98, v82
  v_mul_f32 v92, v100, v84
  v_mul_f32 v94, v102, v86
  v_mul_f32 v96, v104, v88
  v_mul_f32 v91, v98, v83
  v_mul_f32 v93, v100, v85
  v_mul_f32 v95, v102, v87
  v_mul_f32 v97, v104, v89
  v_fma_f32 v90, -v99, v83, v90
  v_fma_f32 v92, -v101, v85, v92
  v_fma_f32 v94, -v103, v87, v94
  v_fma_f32 v96, -v105, v89, v96
  v_fmac_f32 v91, v99, v82
  v_fmac_f32 v93, v101, v84
  v_fmac_f32 v95, v103, v86
  v_fmac_f32 v97, v105, v88
  v_cvt_pk_bf16_f32 v126, v90, v91
  v_cvt_pk_bf16_f32 v127, v92, v93
  v_cvt_pk_bf16_f32 v128, v94, v95
  v_cvt_pk_bf16_f32 v129, v96, v97
  v_mul_f32 v90, v115, v115
  v_mul_f32 v92, v117, v117
  v_mul_f32 v94, v119, v119
  v_mul_f32 v96, v121, v121
  v_mul_f32 v115, v114, v115 mul:2
  v_mul_f32 v117, v116, v117 mul:2
  v_mul_f32 v119, v118, v119 mul:2
  v_mul_f32 v121, v120, v121 mul:2
  v_fma_f32 v114, v114, v114, -v90
  v_fma_f32 v116, v116, v116, -v92
  v_fma_f32 v118, v118, v118, -v94
  v_fma_f32 v120, v120, v120, -v96
  v_mul_f32 v90, v106, v114
  v_mul_f32 v92, v108, v116
  v_mul_f32 v94, v110, v118
  v_mul_f32 v96, v112, v120
  v_mul_f32 v91, v106, v115
  v_mul_f32 v93, v108, v117
  v_mul_f32 v95, v110, v119
  v_mul_f32 v97, v112, v121
  v_fma_f32 v90, -v107, v115, v90
  v_fma_f32 v92, -v109, v117, v92
  v_fma_f32 v94, -v111, v119, v94
  v_fma_f32 v96, -v113, v121, v96
  v_fmac_f32 v91, v107, v114
  v_fmac_f32 v93, v109, v116
  v_fmac_f32 v95, v111, v118
  v_fmac_f32 v97, v113, v120
  v_cvt_pk_bf16_f32 v130, v90, v91
  v_cvt_pk_bf16_f32 v131, v92, v93
  v_cvt_pk_bf16_f32 v132, v94, v95
  v_cvt_pk_bf16_f32 v133, v96, v97
  v_mul_f32 v90, v115, v115
  v_mul_f32 v92, v117, v117
  v_mul_f32 v94, v119, v119
  v_mul_f32 v96, v121, v121
  v_mul_f32 v115, v114, v115 mul:2
  v_mul_f32 v117, v116, v117 mul:2
  v_mul_f32 v119, v118, v119 mul:2
  v_mul_f32 v121, v120, v121 mul:2
  v_fma_f32 v114, v114, v114, -v90
  v_fma_f32 v116, v116, v116, -v92
  v_fma_f32 v118, v118, v118, -v94
  v_fma_f32 v120, v120, v120, -v96
  v_cvt_pk_bf16_f32 v152, v114, -v115
  v_cvt_pk_bf16_f32 v153, v116, -v117
  v_cvt_pk_bf16_f32 v154, v118, -v119
  v_cvt_pk_bf16_f32 v155, v120, -v121
  s_nop 1
  v_mfma_f32_16x16x32_bf16 v[136:139], v[122:125], v[152:155], 0
  v_mfma_f32_16x16x32_bf16 v[140:143], v[126:129], v[152:155], 0
  v_mfma_f32_16x16x32_bf16 v[144:147], v[130:133], v[152:155], 0
  s_waitcnt vmcnt(0)
  s_cmp_lg_u32 s50, 0
  s_cbranch_scc1 LB_zok
  s_mov_b32 s66, 0
LB_zpoll:
  s_waitcnt vmcnt(0)
  v_readfirstlane_b32 s53, v18
  s_nop 0
  s_cmp_lg_u32 s53, 0
  s_cbranch_scc1 LB_zok
  s_add_u32 s66, s66, 1
  s_cmp_gt_u32 s66, 262144
  s_cbranch_scc1 LB_zok
  s_sleep 8
  global_load_dword v18, v19, s[38:39] offset:32 sc1
  s_branch LB_zpoll
LB_zok:
  s_barrier
  s_cmp_lg_u32 s50, 0
  s_cbranch_scc1 LB_h4ar
  v_mov_b32 v19, s71
  s_mov_b64 exec, 1
  global_atomic_add v18, v17, v19, s[40:41] sc0
  s_mov_b64 exec, -1
LB_h4ar:
  ds_read_b128 v[74:77], v31 offset:2336
  ds_read_b128 v[78:81], v31 offset:2352
  ds_read_b128 v[98:101], v44 offset:32
  ds_read_b128 v[102:105], v44 offset:48
  ds_read_b128 v[106:109], v45 offset:32
  ds_read_b128 v[110:113], v45 offset:48
  s_waitcnt lgkmcnt(6)
  v_mul_f32 v90, v66, v64
  v_mul_f32 v91, v67, v64
  v_mul_f32 v92, v68, v64
  v_mul_f32 v93, v69, v64
  v_mul_f32 v94, v70, v64
  v_mul_f32 v95, v71, v64
  v_mul_f32 v96, v72, v64
  v_mul_f32 v97, v73, v64
  ds_read_b128 v[66:69], v31 offset:64
  ds_read_b128 v[70:73], v31 offset:80
  v_fract_f32 v91, v91
  v_fract_f32 v93, v93
  v_fract_f32 v95, v95
  v_fract_f32 v97, v97
  v_exp_f32 v90, v90
  v_exp_f32 v92, v92
  v_exp_f32 v94, v94
  v_exp_f32 v96, v96
  v_cos_f32 v82, v91
  v_cos_f32 v84, v93
  v_cos_f32 v86, v95
  v_cos_f32 v88, v97
  v_sin_f32 v83, v91
  v_sin_f32 v85, v93
  v_sin_f32 v87, v95
  v_sin_f32 v89, v97
  s_nop 1
  v_mul_f32 v82, v82, v90
  v_mul_f32 v83, v83, v90
  v_mul_f32 v84, v84, v92
  v_mul_f32 v85, v85, v92
  v_mul_f32 v86, v86, v94
  v_mul_f32 v87, v87, v94
  v_mul_f32 v88, v88, v96
  v_mul_f32 v89, v89, v96
  s_waitcnt lgkmcnt(2)
  v_mul_f32 v90, v74, v82
  v_mul_f32 v92, v76, v84
  v_mul_f32 v94, v78, v86
  v_mul_f32 v96, v80, v88
  v_mul_f32 v91, v74, v83
  v_mul_f32 v93, v76, v85
  v_mul_f32 v95, v78, v87
  v_mul_f32 v97, v80, v89
  v_fma_f32 v90, -v75, v83, v90
  v_fma_f32 v92, -v77, v85, v92
  v_fma_f32 v94, -v79, v87, v94
  v_fma_f32 v96, -v81, v89, v96
  v_fmac_f32 v91, v75, v82
  v_fmac_f32 v93, v77, v84
  v_fmac_f32 v95, v79, v86
  v_fmac_f32 v97, v81, v88
  v_cvt_pk_bf16_f32 v122, v90, v91
  v_cvt_pk_bf16_f32 v123, v92, v93
  v_cvt_pk_bf16_f32 v124, v94, v95
  v_cvt_pk_bf16_f32 v125, v96, v97
  v_mul_f32 v90, v83, v83
  v_mul_f32 v92, v85, v85
  v_mul_f32 v94, v87, v87
  v_mul_f32 v96, v89, v89
  v_mul_f32 v83, v82, v83 mul:2
  v_mul_f32 v85, v84, v85 mul:2
  v_mul_f32 v87, v86, v87 mul:2
  v_mul_f32 v89, v88, v89 mul:2
  v_fma_f32 v82, v82, v82, -v90
  v_fma_f32 v84, v84, v84, -v92
  v_fma_f32 v86, v86, v86, -v94
  v_fma_f32 v88, v88, v88, -v96
  v_mul_f32 v90, v83, v83
  v_mul_f32 v92, v85, v85
  v_mul_f32 v94, v87, v87
  v_mul_f32 v96, v89, v89
  v_mul_f32 v115, v82, v83 mul:2
  v_mul_f32 v117, v84, v85 mul:2
  v_mul_f32 v119, v86, v87 mul:2
  v_mul_f32 v121, v88, v89 mul:2
  v_fma_f32 v114, v82, v82, -v90
  v_fma_f32 v116, v84, v84, -v92
  v_fma_f32 v118, v86, v86, -v94
  v_fma_f32 v120, v88, v88, -v96
  s_cmp_lg_u32 s50, 0
  s_cbranch_scc1 LB_h5ck
  s_waitcnt vmcnt(0)
  v_readfirstlane_b32 s53, v18
  s_nop 0
  s_and_b32 s54, s53, 0xff
  s_cmp_lg_u32 s54, 31
  s_cbranch_scc1 LB_h5ck
  s_add_u32 s53, s53, s71
  v_mov_b32 v18, s53
  s_lshl_b32 s54, s71, 5
  s_mov_b64 exec, 1
  s_cmp_lg_u32 s53, s54
  s_cbranch_scc1 LB_ck1
  global_store_dword v17, v18, s[40:41] offset:128
  s_branch LB_ck2
LB_ck1:
  global_store_dword v17, v18, s[40:41] offset:128 sc1
LB_ck2:
  s_mov_b64 exec, -1
LB_h5ck:
  v_cndmask_b32 v82, v114, v82, s[74:75]
  v_cndmask_b32 v83, v115, v83, s[74:75]
  v_cndmask_b32 v84, v116, v84, s[74:75]
  v_cndmask_b32 v85, v117, v85, s[74:75]
  v_cndmask_b32 v86, v118, v86, s[74:75]
  v_cndmask_b32 v87, v119, v87, s[74:75]
  v_cndmask_b32 v88, v120, v88, s[74:75]
  v_cndmask_b32 v89, v121, v89, s[74:75]
  v_mul_f32 v90, v98, v82
  v_mul_f32 v92, v100, v84
  v_mul_f32 v94, v102, v86
  v_mul_f32 v96, v104, v88
  v_mul_f32 v91, v98, v83
  v_mul_f32 v93, v100, v85
  v_mul_f32 v95, v102, v87
  v_mul_f32 v97, v104, v89
  v_fma_f32 v90, -v99, v83, v90
  v_fma_f32 v92, -v101, v85, v92
  v_fma_f32 v94, -v103, v87, v94
  v_fma_f32 v96, -v105, v89, v96
  v_fmac_f32 v91, v99, v82
  v_fmac_f32 v93, v101, v84
  v_fmac_f32 v95, v103, v86
  v_fmac_f32 v97, v105, v88
  v_cvt_pk_bf16_f32 v126, v90, v91
  v_cvt_pk_bf16_f32 v127, v92, v93
  v_cvt_pk_bf16_f32 v128, v94, v95
  v_cvt_pk_bf16_f32 v129, v96, v97
  v_mul_f32 v90, v115, v115
  v_mul_f32 v92, v117, v117
  v_mul_f32 v94, v119, v119
  v_mul_f32 v96, v121, v121
  v_mul_f32 v115, v114, v115 mul:2
  v_mul_f32 v117, v116, v117 mul:2
  v_mul_f32 v119, v118, v119 mul:2
  v_mul_f32 v121, v120, v121 mul:2
  v_fma_f32 v114, v114, v114, -v90
  v_fma_f32 v116, v116, v116, -v92
  v_fma_f32 v118, v118, v118, -v94
  v_fma_f32 v120, v120, v120, -v96
  v_mul_f32 v90, v106, v114
  v_mul_f32 v92, v108, v116
  v_mul_f32 v94, v110, v118
  v_mul_f32 v96, v112, v120
  v_mul_f32 v91, v106, v115
  v_mul_f32 v93, v108, v117
  v_mul_f32 v95, v110, v119
  v_mul_f32 v97, v112, v121
  v_fma_f32 v90, -v107, v115, v90
  v_fma_f32 v92, -v109, v117, v92
  v_fma_f32 v94, -v111, v119, v94
  v_fma_f32 v96, -v113, v121, v96
  v_fmac_f32 v91, v107, v114
  v_fmac_f32 v93, v109, v116
  v_fmac_f32 v95, v111, v118
  v_fmac_f32 v97, v113, v120
  v_cvt_pk_bf16_f32 v130, v90, v91
  v_cvt_pk_bf16_f32 v131, v92, v93
  v_cvt_pk_bf16_f32 v132, v94, v95
  v_cvt_pk_bf16_f32 v133, v96, v97
  v_mul_f32 v90, v115, v115
  v_mul_f32 v92, v117, v117
  v_mul_f32 v94, v119, v119
  v_mul_f32 v96, v121, v121
  v_mul_f32 v115, v114, v115 mul:2
  v_mul_f32 v117, v116, v117 mul:2
  v_mul_f32 v119, v118, v119 mul:2
  v_mul_f32 v121, v120, v121 mul:2
  v_fma_f32 v114, v114, v114, -v90
  v_fma_f32 v116, v116, v116, -v92
  v_fma_f32 v118, v118, v118, -v94
  v_fma_f32 v120, v120, v120, -v96
  v_cvt_pk_bf16_f32 v152, v114, -v115
  v_cvt_pk_bf16_f32 v153, v116, -v117
  v_cvt_pk_bf16_f32 v154, v118, -v119
  v_cvt_pk_bf16_f32 v155, v120, -v121
  s_nop 1
  v_mfma_f32_16x16x32_bf16 v[136:139], v[122:125], v[152:155], v[136:139]
  v_mfma_f32_16x16x32_bf16 v[140:143], v[126:129], v[152:155], v[140:143]
  v_mfma_f32_16x16x32_bf16 v[144:147], v[130:133], v[152:155], v[144:147]
  global_load_dword v18, v17, s[40:41] offset:128 sc1
LB_h6pl:
  ds_read_b128 v[74:77], v31 offset:2368
  ds_read_b128 v[78:81], v31 offset:2384
  ds_read_b128 v[98:101], v44 offset:64
  ds_read_b128 v[102:105], v44 offset:80
  ds_read_b128 v[106:109], v45 offset:64
  ds_read_b128 v[110:113], v45 offset:80
  s_waitcnt lgkmcnt(6)
  v_mul_f32 v90, v66, v64
  v_mul_f32 v91, v67, v64
  v_mul_f32 v92, v68, v64
  v_mul_f32 v93, v69, v64
  v_mul_f32 v94, v70, v64
  v_mul_f32 v95, v71, v64
  v_mul_f32 v96, v72, v64
  v_mul_f32 v97, v73, v64
  ds_read_b128 v[66:69], v31 offset:96
  ds_read_b128 v[70:73], v31 offset:112
  v_fract_f32 v91, v91
  v_fract_f32 v93, v93
  v_fract_f32 v95, v95
  v_fract_f32 v97, v97
  v_exp_f32 v90, v90
  v_exp_f32 v92, v92
  v_exp_f32 v94, v94
  v_exp_f32 v96, v96
  v_cos_f32 v82, v91
  v_cos_f32 v84, v93
  v_cos_f32 v86, v95
  v_cos_f32 v88, v97
  v_sin_f32 v83, v91
  v_sin_f32 v85, v93
  v_sin_f32 v87, v95
  v_sin_f32 v89, v97
  s_nop 1
  v_mul_f32 v82, v82, v90
  v_mul_f32 v83, v83, v90
  v_mul_f32 v84, v84, v92
  v_mul_f32 v85, v85, v92
  v_mul_f32 v86, v86, v94
  v_mul_f32 v87, v87, v94
  v_mul_f32 v88, v88, v96
  v_mul_f32 v89, v89, v96
  s_waitcnt lgkmcnt(2)
  v_mul_f32 v90, v74, v82
  v_mul_f32 v92, v76, v84
  v_mul_f32 v94, v78, v86
  v_mul_f32 v96, v80, v88
  v_mul_f32 v91, v74, v83
  v_mul_f32 v93, v76, v85
  v_mul_f32 v95, v78, v87
  v_mul_f32 v97, v80, v89
  v_fma_f32 v90, -v75, v83, v90
  v_fma_f32 v92, -v77, v85, v92
  v_fma_f32 v94, -v79, v87, v94
  v_fma_f32 v96, -v81, v89, v96
  v_fmac_f32 v91, v75, v82
  v_fmac_f32 v93, v77, v84
  v_fmac_f32 v95, v79, v86
  v_fmac_f32 v97, v81, v88
  v_cvt_pk_bf16_f32 v122, v90, v91
  v_cvt_pk_bf16_f32 v123, v92, v93
  v_cvt_pk_bf16_f32 v124, v94, v95
  v_cvt_pk_bf16_f32 v125, v96, v97
  v_mul_f32 v90, v83, v83
  v_mul_f32 v92, v85, v85
  v_mul_f32 v94, v87, v87
  v_mul_f32 v96, v89, v89
  v_mul_f32 v83, v82, v83 mul:2
  v_mul_f32 v85, v84, v85 mul:2
  v_mul_f32 v87, v86, v87 mul:2
  v_mul_f32 v89, v88, v89 mul:2
  v_fma_f32 v82, v82, v82, -v90
  v_fma_f32 v84, v84, v84, -v92
  v_fma_f32 v86, v86, v86, -v94
  v_fma_f32 v88, v88, v88, -v96
  v_mul_f32 v90, v83, v83
  v_mul_f32 v92, v85, v85
  v_mul_f32 v94, v87, v87
  v_mul_f32 v96, v89, v89
  v_mul_f32 v115, v82, v83 mul:2
  v_mul_f32 v117, v84, v85 mul:2
  v_mul_f32 v119, v86, v87 mul:2
  v_mul_f32 v121, v88, v89 mul:2
  v_fma_f32 v114, v82, v82, -v90
  v_fma_f32 v116, v84, v84, -v92
  v_fma_f32 v118, v86, v86, -v94
  v_fma_f32 v120, v88, v88, -v96
  s_getreg_b32 s53, hwreg(HW_REG_IB_STS, 0, 4)
  s_or_b32 s53, s53, s69
  s_cbranch_scc1 LB_h7c4
  s_waitcnt vmcnt(0)
  v_readfirstlane_b32 s53, v18
  s_nop 0
  s_cmp_eq_u32 s53, 0
  s_cbranch_scc1 LB_ucc4
  s_lshl_b32 s54, s71, 5
  s_sub_u32 s72, s53, s54
  s_mov_b32 s69, 1
  s_mul_i32 s53, s51, 9728
  s_mul_i32 s54, s52, 4872
  s_add_u32 s53, s53, s54
  s_add_u32 m0, s53, 16896
  s_mul_i32 s53, s51, 4224
  s_lshl_b32 s54, s52, 2
  s_add_u32 s53, s53, s54
  buffer_load_dwordx4 v16, s[44:47], s53 offen offset:0 sc1 lds
  buffer_load_dwordx4 v16, s[44:47], s53 offen offset:1024 sc1 lds
  buffer_load_dwordx4 v16, s[44:47], s53 offen offset:2048 sc1 lds
  buffer_load_dwordx4 v16, s[44:47], s53 offen offset:3072 sc1 lds
  s_branch LB_h7c4
LB_ucc4:
  global_load_dword v18, v17, s[40:41] offset:128 sc1
LB_h7c4:
  v_cndmask_b32 v82, v114, v82, s[74:75]
  v_cndmask_b32 v83, v115, v83, s[74:75]
  v_cndmask_b32 v84, v116, v84, s[74:75]
  v_cndmask_b32 v85, v117, v85, s[74:75]
  v_cndmask_b32 v86, v118, v86, s[74:75]
  v_cndmask_b32 v87, v119, v87, s[74:75]
  v_cndmask_b32 v88, v120, v88, s[74:75]
  v_cndmask_b32 v89, v121, v89, s[74:75]
  v_mul_f32 v90, v98, v82
  v_mul_f32 v92, v100, v84
  v_mul_f32 v94, v102, v86
  v_mul_f32 v96, v104, v88
  v_mul_f32 v91, v98, v83
  v_mul_f32 v93, v100, v85
  v_mul_f32 v95, v102, v87
  v_mul_f32 v97, v104, v89
  v_fma_f32 v90, -v99, v83, v90
  v_fma_f32 v92, -v101, v85, v92
  v_fma_f32 v94, -v103, v87, v94
  v_fma_f32 v96, -v105, v89, v96
  v_fmac_f32 v91, v99, v82
  v_fmac_f32 v93, v101, v84
  v_fmac_f32 v95, v103, v86
  v_fmac_f32 v97, v105, v88
  v_cvt_pk_bf16_f32 v126, v90, v91
  v_cvt_pk_bf16_f32 v127, v92, v93
  v_cvt_pk_bf16_f32 v128, v94, v95
  v_cvt_pk_bf16_f32 v129, v96, v97
  v_mul_f32 v90, v115, v115
  v_mul_f32 v92, v117, v117
  v_mul_f32 v94, v119, v119
  v_mul_f32 v96, v121, v121
  v_mul_f32 v115, v114, v115 mul:2
  v_mul_f32 v117, v116, v117 mul:2
  v_mul_f32 v119, v118, v119 mul:2
  v_mul_f32 v121, v120, v121 mul:2
  v_fma_f32 v114, v114, v114, -v90
  v_fma_f32 v116, v116, v116, -v92
  v_fma_f32 v118, v118, v118, -v94
  v_fma_f32 v120, v120, v120, -v96
  v_mul_f32 v90, v106, v114
  v_mul_f32 v92, v108, v116
  v_mul_f32 v94, v110, v118
  v_mul_f32 v96, v112, v120
  v_mul_f32 v91, v106, v115
  v_mul_f32 v93, v108, v117
  v_mul_f32 v95, v110, v119
  v_mul_f32 v97, v112, v121
  v_fma_f32 v90, -v107, v115, v90
  v_fma_f32 v92, -v109, v117, v92
  v_fma_f32 v94, -v111, v119, v94
  v_fma_f32 v96, -v113, v121, v96
  v_fmac_f32 v91, v107, v114
  v_fmac_f32 v93, v109, v116
  v_fmac_f32 v95, v111, v118
  v_fmac_f32 v97, v113, v120
  v_cvt_pk_bf16_f32 v130, v90, v91
  v_cvt_pk_bf16_f32 v131, v92, v93
  v_cvt_pk_bf16_f32 v132, v94, v95
  v_cvt_pk_bf16_f32 v133, v96, v97
  v_mul_f32 v90, v115, v115
  v_mul_f32 v92, v117, v117
  v_mul_f32 v94, v119, v119
  v_mul_f32 v96, v121, v121
  v_mul_f32 v115, v114, v115 mul:2
  v_mul_f32 v117, v116, v117 mul:2
  v_mul_f32 v119, v118, v119 mul:2
  v_mul_f32 v121, v120, v121 mul:2
  v_fma_f32 v114, v114, v114, -v90
  v_fma_f32 v116, v116, v116, -v92
  v_fma_f32 v118, v118, v118, -v94
  v_fma_f32 v120, v120, v120, -v96
  v_cvt_pk_bf16_f32 v152, v114, -v115
  v_cvt_pk_bf16_f32 v153, v116, -v117
  v_cvt_pk_bf16_f32 v154, v118, -v119
  v_cvt_pk_bf16_f32 v155, v120, -v121
  s_nop 1
  v_mfma_f32_16x16x32_bf16 v[136:139], v[122:125], v[152:155], v[136:139]
  v_mfma_f32_16x16x32_bf16 v[140:143], v[126:129], v[152:155], v[140:143]
  v_mfma_f32_16x16x32_bf16 v[144:147], v[130:133], v[152:155], v[144:147]
  s_getreg_b32 s53, hwreg(HW_REG_IB_STS, 0, 4)
  s_or_b32 s53, s53, s69
  s_cbranch_scc1 LB_h8c5
  s_waitcnt vmcnt(0)
  v_readfirstlane_b32 s53, v18
  s_nop 0
  s_cmp_eq_u32 s53, 0
  s_cbranch_scc1 LB_ucc5
  s_lshl_b32 s54, s71, 5
  s_sub_u32 s72, s53, s54
  s_mov_b32 s69, 1
  s_mul_i32 s53, s51, 9728
  s_mul_i32 s54, s52, 4872
  s_add_u32 s53, s53, s54
  s_add_u32 m0, s53, 16896
  s_mul_i32 s53, s51, 4224
  s_lshl_b32 s54, s52, 2
  s_add_u32 s53, s53, s54
  buffer_load_dwordx4 v16, s[44:47], s53 offen offset:0 sc1 lds
  buffer_load_dwordx4 v16, s[44:47], s53 offen offset:1024 sc1 lds
  buffer_load_dwordx4 v16, s[44:47], s53 offen offset:2048 sc1 lds
  buffer_load_dwordx4 v16, s[44:47], s53 offen offset:3072 sc1 lds
  s_branch LB_h8c5
LB_ucc5:
  global_load_dword v18, v17, s[40:41] offset:128 sc1
LB_h8c5:
  ds_read_b128 v[74:77], v31 offset:2400
  ds_read_b128 v[78:81], v31 offset:2416
  ds_read_b128 v[98:101], v44 offset:96
  ds_read_b128 v[102:105], v44 offset:112
  ds_read_b128 v[106:109], v45 offset:96
  ds_read_b128 v[110:113], v45 offset:112
  s_waitcnt lgkmcnt(6)
  v_mul_f32 v90, v66, v64
  v_mul_f32 v91, v67, v64
  v_mul_f32 v92, v68, v64
  v_mul_f32 v93, v69, v64
  v_mul_f32 v94, v70, v64
  v_mul_f32 v95, v71, v64
  v_mul_f32 v96, v72, v64
  v_mul_f32 v97, v73, v64
  v_fract_f32 v91, v91
  v_fract_f32 v93, v93
  v_fract_f32 v95, v95
  v_fract_f32 v97, v97
  v_exp_f32 v90, v90
  v_exp_f32 v92, v92
  v_exp_f32 v94, v94
  v_exp_f32 v96, v96
  v_cos_f32 v82, v91
  v_cos_f32 v84, v93
  v_cos_f32 v86, v95
  v_cos_f32 v88, v97
  v_sin_f32 v83, v91
  v_sin_f32 v85, v93
  v_sin_f32 v87, v95
  v_sin_f32 v89, v97
  s_nop 1
  v_mul_f32 v82, v82, v90
  v_mul_f32 v83, v83, v90
  v_mul_f32 v84, v84, v92
  v_mul_f32 v85, v85, v92
  v_mul_f32 v86, v86, v94
  v_mul_f32 v87, v87, v94
  v_mul_f32 v88, v88, v96
  v_mul_f32 v89, v89, v96
  s_waitcnt lgkmcnt(0)
  v_mul_f32 v90, v74, v82
  v_mul_f32 v92, v76, v84
  v_mul_f32 v94, v78, v86
  v_mul_f32 v96, v80, v88
  v_mul_f32 v91, v74, v83
  v_mul_f32 v93, v76, v85
  v_mul_f32 v95, v78, v87
  v_mul_f32 v97, v80, v89
  v_fma_f32 v90, -v75, v83, v90
  v_fma_f32 v92, -v77, v85, v92
  v_fma_f32 v94, -v79, v87, v94
  v_fma_f32 v96, -v81, v89, v96
  v_fmac_f32 v91, v75, v82
  v_fmac_f32 v93, v77, v84
  v_fmac_f32 v95, v79, v86
  v_fmac_f32 v97, v81, v88
  v_cvt_pk_bf16_f32 v122, v90, v91
  v_cvt_pk_bf16_f32 v123, v92, v93
  v_cvt_pk_bf16_f32 v124, v94, v95
  v_cvt_pk_bf16_f32 v125, v96, v97
  v_mul_f32 v90, v83, v83
  v_mul_f32 v92, v85, v85
  v_mul_f32 v94, v87, v87
  v_mul_f32 v96, v89, v89
  v_mul_f32 v83, v82, v83 mul:2
  v_mul_f32 v85, v84, v85 mul:2
  v_mul_f32 v87, v86, v87 mul:2
  v_mul_f32 v89, v88, v89 mul:2
  v_fma_f32 v82, v82, v82, -v90
  v_fma_f32 v84, v84, v84, -v92
  v_fma_f32 v86, v86, v86, -v94
  v_fma_f32 v88, v88, v88, -v96
  v_mul_f32 v90, v83, v83
  v_mul_f32 v92, v85, v85
  v_mul_f32 v94, v87, v87
  v_mul_f32 v96, v89, v89
  v_mul_f32 v115, v82, v83 mul:2
  v_mul_f32 v117, v84, v85 mul:2
  v_mul_f32 v119, v86, v87 mul:2
  v_mul_f32 v121, v88, v89 mul:2
  v_fma_f32 v114, v82, v82, -v90
  v_fma_f32 v116, v84, v84, -v92
  v_fma_f32 v118, v86, v86, -v94
  v_fma_f32 v120, v88, v88, -v96
  s_getreg_b32 s53, hwreg(HW_REG_IB_STS, 0, 4)
  s_or_b32 s53, s53, s69
  s_cbranch_scc1 LB_h9c6
  s_waitcnt vmcnt(0)
  v_readfirstlane_b32 s53, v18
  s_nop 0
  s_cmp_eq_u32 s53, 0
  s_cbranch_scc1 LB_ucc6
  s_lshl_b32 s54, s71, 5
  s_sub_u32 s72, s53, s54
  s_mov_b32 s69, 1
  s_mul_i32 s53, s51, 9728
  s_mul_i32 s54, s52, 4872
  s_add_u32 s53, s53, s54
  s_add_u32 m0, s53, 16896
  s_mul_i32 s53, s51, 4224
  s_lshl_b32 s54, s52, 2
  s_add_u32 s53, s53, s54
  buffer_load_dwordx4 v16, s[44:47], s53 offen offset:0 sc1 lds
  buffer_load_dwordx4 v16, s[44:47], s53 offen offset:1024 sc1 lds
  buffer_load_dwordx4 v16, s[44:47], s53 offen offset:2048 sc1 lds
  buffer_load_dwordx4 v16, s[44:47], s53 offen offset:3072 sc1 lds
  s_branch LB_h9c6
LB_ucc6:
  global_load_dword v18, v17, s[40:41] offset:128 sc1
LB_h9c6:
  v_cndmask_b32 v82, v114, v82, s[74:75]
  v_cndmask_b32 v83, v115, v83, s[74:75]
  v_cndmask_b32 v84, v116, v84, s[74:75]
  v_cndmask_b32 v85, v117, v85, s[74:75]
  v_cndmask_b32 v86, v118, v86, s[74:75]
  v_cndmask_b32 v87, v119, v87, s[74:75]
  v_cndmask_b32 v88, v120, v88, s[74:75]
  v_cndmask_b32 v89, v121, v89, s[74:75]
  v_mul_f32 v90, v98, v82
  v_mul_f32 v92, v100, v84
  v_mul_f32 v94, v102, v86
  v_mul_f32 v96, v104, v88
  v_mul_f32 v91, v98, v83
  v_mul_f32 v93, v100, v85
  v_mul_f32 v95, v102, v87
  v_mul_f32 v97, v104, v89
  v_fma_f32 v90, -v99, v83, v90
  v_fma_f32 v92, -v101, v85, v92
  v_fma_f32 v94, -v103, v87, v94
  v_fma_f32 v96, -v105, v89, v96
  v_fmac_f32 v91, v99, v82
  v_fmac_f32 v93, v101, v84
  v_fmac_f32 v95, v103, v86
  v_fmac_f32 v97, v105, v88
  v_cvt_pk_bf16_f32 v126, v90, v91
  v_cvt_pk_bf16_f32 v127, v92, v93
  v_cvt_pk_bf16_f32 v128, v94, v95
  v_cvt_pk_bf16_f32 v129, v96, v97
  v_mul_f32 v90, v115, v115
  v_mul_f32 v92, v117, v117
  v_mul_f32 v94, v119, v119
  v_mul_f32 v96, v121, v121
  v_mul_f32 v115, v114, v115 mul:2
  v_mul_f32 v117, v116, v117 mul:2
  v_mul_f32 v119, v118, v119 mul:2
  v_mul_f32 v121, v120, v121 mul:2
  v_fma_f32 v114, v114, v114, -v90
  v_fma_f32 v116, v116, v116, -v92
  v_fma_f32 v118, v118, v118, -v94
  v_fma_f32 v120, v120, v120, -v96
  v_mul_f32 v90, v106, v114
  v_mul_f32 v92, v108, v116
  v_mul_f32 v94, v110, v118
  v_mul_f32 v96, v112, v120
  v_mul_f32 v91, v106, v115
  v_mul_f32 v93, v108, v117
  v_mul_f32 v95, v110, v119
  v_mul_f32 v97, v112, v121
  v_fma_f32 v90, -v107, v115, v90
  v_fma_f32 v92, -v109, v117, v92
  v_fma_f32 v94, -v111, v119, v94
  v_fma_f32 v96, -v113, v121, v96
  v_fmac_f32 v91, v107, v114
  v_fmac_f32 v93, v109, v116
  v_fmac_f32 v95, v111, v118
  v_fmac_f32 v97, v113, v120
  v_cvt_pk_bf16_f32 v130, v90, v91
  v_cvt_pk_bf16_f32 v131, v92, v93
  v_cvt_pk_bf16_f32 v132, v94, v95
  v_cvt_pk_bf16_f32 v133, v96, v97
  v_mul_f32 v90, v115, v115
  v_mul_f32 v92, v117, v117
  v_mul_f32 v94, v119, v119
  v_mul_f32 v96, v121, v121
  v_mul_f32 v115, v114, v115 mul:2
  v_mul_f32 v117, v116, v117 mul:2
  v_mul_f32 v119, v118, v119 mul:2
  v_mul_f32 v121, v120, v121 mul:2
  v_fma_f32 v114, v114, v114, -v90
  v_fma_f32 v116, v116, v116, -v92
  v_fma_f32 v118, v118, v118, -v94
  v_fma_f32 v120, v120, v120, -v96
  v_cvt_pk_bf16_f32 v152, v114, -v115
  v_cvt_pk_bf16_f32 v153, v116, -v117
  v_cvt_pk_bf16_f32 v154, v118, -v119
  v_cvt_pk_bf16_f32 v155, v120, -v121
  s_nop 1
  v_mfma_f32_16x16x32_bf16 v[136:139], v[122:125], v[152:155], v[136:139]
  v_mfma_f32_16x16x32_bf16 v[140:143], v[126:129], v[152:155], v[140:143]
  v_mfma_f32_16x16x32_bf16 v[144:147], v[130:133], v[152:155], v[144:147]
  s_getreg_b32 s53, hwreg(HW_REG_IB_STS, 0, 4)
  s_or_b32 s53, s53, s69
  s_cbranch_scc1 LB_h10c7
  s_waitcnt vmcnt(0)
  v_readfirstlane_b32 s53, v18
  s_nop 0
  s_cmp_eq_u32 s53, 0
  s_cbranch_scc1 LB_ucc7
  s_lshl_b32 s54, s71, 5
  s_sub_u32 s72, s53, s54
  s_mov_b32 s69, 1
  s_mul_i32 s53, s51, 9728
  s_mul_i32 s54, s52, 4872
  s_add_u32 s53, s53, s54
  s_add_u32 m0, s53, 16896
  s_mul_i32 s53, s51, 4224
  s_lshl_b32 s54, s52, 2
  s_add_u32 s53, s53, s54
  buffer_load_dwordx4 v16, s[44:47], s53 offen offset:0 sc1 lds
  buffer_load_dwordx4 v16, s[44:47], s53 offen offset:1024 sc1 lds
  buffer_load_dwordx4 v16, s[44:47], s53 offen offset:2048 sc1 lds
  buffer_load_dwordx4 v16, s[44:47], s53 offen offset:3072 sc1 lds
  s_branch LB_h10c7
LB_ucc7:
  global_load_dword v18, v17, s[40:41] offset:128 sc1
LB_h10c7:
  s_nop 2
  ds_write_b128 v46, v[136:139]
  ds_write_b128 v47, v[140:143]
  ds_write_b64 v48, v[144:145]
  ds_write_b64 v48, v[146:147] offset:128
  s_mov_b32 s60, 0x01000100
  s_mov_b32 s61, 0x03020302
  s_waitcnt lgkmcnt(0)
  s_barrier
  ds_read_b128 v[66:69], v32
  ds_read_b128 v[70:73], v32 offset:4096
  ds_read_b32 v74, v33
  ds_read_b32 v75, v33 offset:4096
  ds_read_b128 v[78:81], v35
  ds_read_b128 v[82:85], v35 offset:4096
  ds_read_b32 v86, v36
  ds_read_b32 v87, v36 offset:4096
  s_getreg_b32 s53, hwreg(HW_REG_IB_STS, 0, 4)
  s_or_b32 s53, s53, s69
  s_cbranch_scc1 LB_h11c8
  s_waitcnt vmcnt(0)
  v_readfirstlane_b32 s53, v18
  s_nop 0
  s_cmp_eq_u32 s53, 0
  s_cbranch_scc1 LB_ucc8
  s_lshl_b32 s54, s71, 5
  s_sub_u32 s72, s53, s54
  s_mov_b32 s69, 1
  s_mul_i32 s53, s51, 9728
  s_mul_i32 s54, s52, 4872
  s_add_u32 s53, s53, s54
  s_add_u32 m0, s53, 16896
  s_mul_i32 s53, s51, 4224
  s_lshl_b32 s54, s52, 2
  s_add_u32 s53, s53, s54
  buffer_load_dwordx4 v16, s[44:47], s53 offen offset:0 sc1 lds
  buffer_load_dwordx4 v16, s[44:47], s53 offen offset:1024 sc1 lds
  buffer_load_dwordx4 v16, s[44:47], s53 offen offset:2048 sc1 lds
  buffer_load_dwordx4 v16, s[44:47], s53 offen offset:3072 sc1 lds
  s_branch LB_h11c8
LB_ucc8:
  global_load_dword v18, v17, s[40:41] offset:128 sc1
LB_h11c8:
  s_cmp_lg_u32 s52, 0
  s_cbranch_scc1 LB_e1
  s_waitcnt lgkmcnt(4)
  v_add_f32 v66, v66, v70
  v_add_f32 v67, v67, v71
  v_add_f32 v68, v68, v72
  v_add_f32 v69, v69, v73
  v_add_f32 v74, v74, v75
  v_add_f32 v66, v66, v28
  v_cndmask_b32 v74, v74, 0, s[62:63]
  s_mov_b32 s53, 0x01000504
  s_mov_b32 s54, 0x05040302
  v_cvt_pk_bf16_f32 v66, v66, v67
  v_cvt_pk_bf16_f32 v67, v68, v69
  v_cvt_pk_bf16_f32 v68, v74, v74
  ds_write_b64 v34, v[66:67] offset:4224
  v_perm_b32 v70, v68, v66, s53
  v_perm_b32 v71, v67, v66, s54
  ds_write_b64 v34, v[70:71]
  s_waitcnt lgkmcnt(2)
  v_add_f32 v78, v78, v82
  v_add_f32 v79, v79, v83
  v_add_f32 v80, v80, v84
  v_add_f32 v81, v81, v85
  v_add_f32 v86, v86, v87
  v_cvt_pk_bf16_f32 v78, v78, v79
  v_cvt_pk_bf16_f32 v79, v80, v81
  v_cvt_pk_bf16_f32 v80, v86, v86
  v_perm_b32 v96, v78, v78, s60
  v_perm_b32 v97, v78, v78, s60
  v_perm_b32 v98, v78, v78, v40
  v_perm_b32 v99, v78, v78, s61
  ds_write_b128 v37, v[96:99] offset:0
  v_perm_b32 v100, v78, v78, s61
  v_perm_b32 v101, v78, v78, s61
  v_perm_b32 v102, v79, v78, v41
  v_perm_b32 v103, v79, v79, s60
  ds_write_b128 v37, v[100:103] offset:16
  v_perm_b32 v104, v79, v79, s60
  v_perm_b32 v105, v79, v79, s60
  v_perm_b32 v106, v79, v79, v40
  v_perm_b32 v107, v79, v79, s61
  ds_write_b128 v37, v[104:107] offset:32
  v_perm_b32 v108, v79, v79, s61
  v_perm_b32 v109, v79, v79, s61
  v_perm_b32 v110, v80, v79, v41
  v_mov_b32 v111, v80
  ds_write_b128 v37, v[108:111] offset:48
  s_branch LB_e2
LB_e1:
  s_waitcnt lgkmcnt(4)
  v_add_f32 v66, v66, v70
  v_add_f32 v67, v67, v71
  v_add_f32 v68, v68, v72
  v_add_f32 v69, v69, v73
  v_add_f32 v74, v74, v75
  v_cvt_pk_bf16_f32 v66, v66, v67
  v_cvt_pk_bf16_f32 v67, v68, v69
  v_cvt_pk_bf16_f32 v68, v74, v74
  v_perm_b32 v96, v68, v66, v42
  v_perm_b32 v97, v67, v66, v43
  v_perm_b32 v98, v67, v67, s60
  v_perm_b32 v99, v68, v67, v43
  ds_write_b128 v34, v[96:99]
  s_waitcnt lgkmcnt(1)
  v_add_f32 v78, v78, v82
  v_add_f32 v79, v79, v83
  v_add_f32 v80, v80, v84
  v_add_f32 v81, v81, v85
  v_add_f32 v86, v86, v87
  v_cvt_pk_bf16_f32 v78, v78, v79
  v_cvt_pk_bf16_f32 v79, v80, v81
  v_cvt_pk_bf16_f32 v80, v86, v86
  v_perm_b32 v100, v78, v78, s60
  v_perm_b32 v101, v78, v78, v40
  v_perm_b32 v102, v78, v78, s61
  v_perm_b32 v103, v79, v78, v41
  ds_write_b128 v37, v[100:103] offset:0
  v_perm_b32 v104, v79, v79, s60
  v_perm_b32 v105, v79, v79, v40
  v_perm_b32 v106, v79, v79, s61
  v_perm_b32 v107, v80, v79, v41
  ds_write_b128 v37, v[104:107] offset:16
LB_e2:
  s_cmp_lg_u32 s69, 0
  s_cbranch_scc1 LB_np1
  s_mov_b32 s66, 0
LB_upoll:
  s_waitcnt vmcnt(0)
  v_readfirstlane_b32 s53, v18
  s_nop 0
  s_cmp_lg_u32 s53, 0
  s_cbranch_scc1 LB_uok
  s_add_u32 s66, s66, 1
  s_cmp_gt_u32 s66, 262144
  s_cbranch_scc1 LB_uok
  s_sleep 1
  global_load_dword v18, v17, s[40:41] offset:128 sc1
  s_branch LB_upoll
LB_uok:
  s_lshl_b32 s54, s71, 5
  s_sub_u32 s72, s53, s54
  s_mov_b32 s69, 1
  s_mul_i32 s53, s51, 9728
  s_mul_i32 s54, s52, 4872
  s_add_u32 s53, s53, s54
  s_add_u32 m0, s53, 16896
  s_mul_i32 s53, s51, 4224
  s_lshl_b32 s54, s52, 2
  s_add_u32 s53, s53, s54
  buffer_load_dwordx4 v16, s[44:47], s53 offen offset:0 sc1 lds
  buffer_load_dwordx4 v16, s[44:47], s53 offen offset:1024 sc1 lds
  buffer_load_dwordx4 v16, s[44:47], s53 offen offset:2048 sc1 lds
  buffer_load_dwordx4 v16, s[44:47], s53 offen offset:3072 sc1 lds
LB_np1:
  v_and_b32 v10, 1, v2
  v_bfe_u32 v11, v2, 1, 3
  s_mul_i32 s53, s51, 8448
  s_lshl_b32 s54, s52, 8
  s_add_u32 s53, s53, s54
  s_add_u32 s53, s53, 8
  v_mul_u32_u24 v12, 4224, v10
  v_lshl_add_u32 v12, v11, 3, v12
  v_lshl_add_u32 v12, v30, 4, v12
  v_add_u32 v12, s53, v12
  s_lshl_b32 s54, s52, 5
  s_add_u32 s54, s54, 56
  v_lshlrev_b32 v13, 3, v11
  v_sub_u32 v13, s54, v13
  v_lshl_add_u32 v13, v30, 1, v13
  s_mul_i32 s53, s51, 9728
  s_add_u32 s53, s53, 21768
  v_mul_u32_u24 v14, 4872, v10
  v_sub_u32 v14, s53, v14
  v_mov_b32 v32, 0
  v_mov_b32 v33, 0
  v_mov_b32 v34, 0
  v_mov_b32 v35, 0
  v_mov_b32 v36, 0
  v_mov_b32 v37, 0
  v_mov_b32 v38, 0
  v_mov_b32 v39, 0
  v_mov_b32 v40, 0
  v_mov_b32 v41, 0
  v_mov_b32 v42, 0
  v_mov_b32 v43, 0
  v_mov_b32 v44, 0
  v_mov_b32 v45, 0
  v_mov_b32 v46, 0
  v_mov_b32 v47, 0
  v_mov_b32 v48, 0
  v_mov_b32 v49, 0
  v_mov_b32 v50, 0
  v_mov_b32 v51, 0
  v_mov_b32 v52, 0
  v_mov_b32 v53, 0
  v_mov_b32 v54, 0
  v_mov_b32 v55, 0
  v_mov_b32 v56, 0
  v_mov_b32 v57, 0
  v_mov_b32 v58, 0
  v_mov_b32 v59, 0
  v_mov_b32 v60, 0
  v_mov_b32 v61, 0
  v_mov_b32 v62, 0
  v_mov_b32 v63, 0
  v_lshrrev_b32 v15, 3, v13
  v_and_b32 v15, 4, v15
  v_xor_b32 v15, v15, v13
  v_lshl_add_u32 v15, v15, 3, v14
  s_waitcnt lgkmcnt(0) vmcnt(0)
  s_barrier
  ds_read_b64 v[64:65], v12 offset:0
  ds_read_b64 v[66:67], v12 offset:8
  ds_read_b64 v[96:97], v15 offset:3584
  ds_read_b64 v[98:99], v15 offset:3592
  ds_read_b64 v[68:69], v12 offset:512
  ds_read_b64 v[70:71], v12 offset:520
  ds_read_b64 v[100:101], v15 offset:3072
  ds_read_b64 v[102:103], v15 offset:3080
  ds_read_b64 v[72:73], v12 offset:1024
  ds_read_b64 v[74:75], v12 offset:1032
  ds_read_b64 v[104:105], v15 offset:2560
  ds_read_b64 v[106:107], v15 offset:2568
  ds_read_b64 v[76:77], v12 offset:1536
  ds_read_b64 v[78:79], v12 offset:1544
  ds_read_b64 v[108:109], v15 offset:2048
  ds_read_b64 v[110:111], v15 offset:2056
  ds_read_b64 v[80:81], v12 offset:2048
  ds_read_b64 v[82:83], v12 offset:2056
  ds_read_b64 v[112:113], v15 offset:1536
  ds_read_b64 v[114:115], v15 offset:1544
  ds_read_b64 v[84:85], v12 offset:2560
  ds_read_b64 v[86:87], v12 offset:2568
  ds_read_b64 v[116:117], v15 offset:1024
  ds_read_b64 v[118:119], v15 offset:1032
  ds_read_b64 v[88:89], v12 offset:3072
  ds_read_b64 v[90:91], v12 offset:3080
  ds_read_b64 v[120:121], v15 offset:512
  ds_read_b64 v[122:123], v15 offset:520
  ds_read_b64 v[92:93], v12 offset:3584
  ds_read_b64 v[94:95], v12 offset:3592
  ds_read_b64 v[124:125], v15 offset:0
  ds_read_b64 v[126:127], v15 offset:8
  v_add_u32 v12, 64, v12
  v_add_u32 v13, 8, v13
  v_lshrrev_b32 v15, 3, v13
  v_and_b32 v15, 4, v15
  v_xor_b32 v15, v15, v13
  v_lshl_add_u32 v15, v15, 3, v14
  s_waitcnt lgkmcnt(0)
  v_mfma_f32_16x16x32_bf16 v[32:35], v[64:67], v[96:99], v[32:35]
  ds_read_b64 v[128:129], v12 offset:0
  v_mfma_f32_16x16x32_bf16 v[36:39], v[64:67], v[100:103], v[36:39]
  ds_read_b64 v[130:131], v12 offset:8
  v_mfma_f32_16x16x32_bf16 v[36:39], v[68:71], v[96:99], v[36:39]
  ds_read_b64 v[160:161], v15 offset:3584
  v_mfma_f32_16x16x32_bf16 v[40:43], v[68:71], v[100:103], v[40:43]
  ds_read_b64 v[162:163], v15 offset:3592
  v_mfma_f32_16x16x32_bf16 v[40:43], v[64:67], v[104:107], v[40:43]
  ds_read_b64 v[132:133], v12 offset:512
  v_mfma_f32_16x16x32_bf16 v[44:47], v[68:71], v[104:107], v[44:47]
  ds_read_b64 v[134:135], v12 offset:520
  v_mfma_f32_16x16x32_bf16 v[40:43], v[72:75], v[96:99], v[40:43]
  ds_read_b64 v[164:165], v15 offset:3072
  v_mfma_f32_16x16x32_bf16 v[44:47], v[72:75], v[100:103], v[44:47]
  ds_read_b64 v[166:167], v15 offset:3080
  v_mfma_f32_16x16x32_bf16 v[48:51], v[72:75], v[104:107], v[48:51]
  ds_read_b64 v[136:137], v12 offset:1024
  v_mfma_f32_16x16x32_bf16 v[44:47], v[64:67], v[108:111], v[44:47]
  ds_read_b64 v[138:139], v12 offset:1032
  v_mfma_f32_16x16x32_bf16 v[48:51], v[68:71], v[108:111], v[48:51]
  ds_read_b64 v[168:169], v15 offset:2560
  v_mfma_f32_16x16x32_bf16 v[52:55], v[72:75], v[108:111], v[52:55]
  ds_read_b64 v[170:171], v15 offset:2568
  v_mfma_f32_16x16x32_bf16 v[44:47], v[76:79], v[96:99], v[44:47]
  ds_read_b64 v[140:141], v12 offset:1536
  v_mfma_f32_16x16x32_bf16 v[48:51], v[76:79], v[100:103], v[48:51]
  ds_read_b64 v[142:143], v12 offset:1544
  v_mfma_f32_16x16x32_bf16 v[52:55], v[76:79], v[104:107], v[52:55]
  ds_read_b64 v[172:173], v15 offset:2048
  v_mfma_f32_16x16x32_bf16 v[56:59], v[76:79], v[108:111], v[56:59]
  ds_read_b64 v[174:175], v15 offset:2056
  v_mfma_f32_16x16x32_bf16 v[48:51], v[64:67], v[112:115], v[48:51]
  ds_read_b64 v[144:145], v12 offset:2048
  v_mfma_f32_16x16x32_bf16 v[52:55], v[68:71], v[112:115], v[52:55]
  ds_read_b64 v[146:147], v12 offset:2056
  v_mfma_f32_16x16x32_bf16 v[56:59], v[72:75], v[112:115], v[56:59]
  ds_read_b64 v[176:177], v15 offset:1536
  v_mfma_f32_16x16x32_bf16 v[60:63], v[76:79], v[112:115], v[60:63]
  ds_read_b64 v[178:179], v15 offset:1544
  v_mfma_f32_16x16x32_bf16 v[48:51], v[80:83], v[96:99], v[48:51]
  ds_read_b64 v[148:149], v12 offset:2560
  v_mfma_f32_16x16x32_bf16 v[52:55], v[80:83], v[100:103], v[52:55]
  ds_read_b64 v[150:151], v12 offset:2568
  v_mfma_f32_16x16x32_bf16 v[56:59], v[80:83], v[104:107], v[56:59]
  ds_read_b64 v[180:181], v15 offset:1024
  v_mfma_f32_16x16x32_bf16 v[60:63], v[80:83], v[108:111], v[60:63]
  ds_read_b64 v[182:183], v15 offset:1032
  v_mfma_f32_16x16x32_bf16 v[52:55], v[64:67], v[116:119], v[52:55]
  ds_read_b64 v[152:153], v12 offset:3072
  v_mfma_f32_16x16x32_bf16 v[56:59], v[68:71], v[116:119], v[56:59]
  ds_read_b64 v[154:155], v12 offset:3080
  v_mfma_f32_16x16x32_bf16 v[60:63], v[72:75], v[116:119], v[60:63]
  ds_read_b64 v[184:185], v15 offset:512
  v_mfma_f32_16x16x32_bf16 v[52:55], v[84:87], v[96:99], v[52:55]
  ds_read_b64 v[186:187], v15 offset:520
  v_mfma_f32_16x16x32_bf16 v[56:59], v[84:87], v[100:103], v[56:59]
  ds_read_b64 v[156:157], v12 offset:3584
  v_mfma_f32_16x16x32_bf16 v[60:63], v[84:87], v[104:107], v[60:63]
  ds_read_b64 v[158:159], v12 offset:3592
  v_mfma_f32_16x16x32_bf16 v[56:59], v[64:67], v[120:123], v[56:59]
  ds_read_b64 v[188:189], v15 offset:0
  v_mfma_f32_16x16x32_bf16 v[60:63], v[68:71], v[120:123], v[60:63]
  ds_read_b64 v[190:191], v15 offset:8
  v_mfma_f32_16x16x32_bf16 v[56:59], v[88:91], v[96:99], v[56:59]
  v_mfma_f32_16x16x32_bf16 v[60:63], v[88:91], v[100:103], v[60:63]
  v_mfma_f32_16x16x32_bf16 v[60:63], v[64:67], v[124:127], v[60:63]
  v_mfma_f32_16x16x32_bf16 v[60:63], v[92:95], v[96:99], v[60:63]
  v_add_u32 v12, 64, v12
  v_add_u32 v13, 8, v13
  v_lshrrev_b32 v15, 3, v13
  v_and_b32 v15, 4, v15
  v_xor_b32 v15, v15, v13
  v_lshl_add_u32 v15, v15, 3, v14
  s_waitcnt lgkmcnt(0)
  v_mfma_f32_16x16x32_bf16 v[32:35], v[128:131], v[160:163], v[32:35]
  ds_read_b64 v[64:65], v12 offset:0
  v_mfma_f32_16x16x32_bf16 v[36:39], v[128:131], v[164:167], v[36:39]
  ds_read_b64 v[66:67], v12 offset:8
  v_mfma_f32_16x16x32_bf16 v[36:39], v[132:135], v[160:163], v[36:39]
  ds_read_b64 v[96:97], v15 offset:3584
  v_mfma_f32_16x16x32_bf16 v[40:43], v[132:135], v[164:167], v[40:43]
  ds_read_b64 v[98:99], v15 offset:3592
  v_mfma_f32_16x16x32_bf16 v[40:43], v[128:131], v[168:171], v[40:43]
  ds_read_b64 v[68:69], v12 offset:512
  v_mfma_f32_16x16x32_bf16 v[44:47], v[132:135], v[168:171], v[44:47]
  ds_read_b64 v[70:71], v12 offset:520
  v_mfma_f32_16x16x32_bf16 v[40:43], v[136:139], v[160:163], v[40:43]
  ds_read_b64 v[100:101], v15 offset:3072
  v_mfma_f32_16x16x32_bf16 v[44:47], v[136:139], v[164:167], v[44:47]
  ds_read_b64 v[102:103], v15 offset:3080
  v_mfma_f32_16x16x32_bf16 v[48:51], v[136:139], v[168:171], v[48:51]
  ds_read_b64 v[72:73], v12 offset:1024
  v_mfma_f32_16x16x32_bf16 v[44:47], v[128:131], v[172:175], v[44:47]
  ds_read_b64 v[74:75], v12 offset:1032
  v_mfma_f32_16x16x32_bf16 v[48:51], v[132:135], v[172:175], v[48:51]
  ds_read_b64 v[104:105], v15 offset:2560
  v_mfma_f32_16x16x32_bf16 v[52:55], v[136:139], v[172:175], v[52:55]
  ds_read_b64 v[106:107], v15 offset:2568
  v_mfma_f32_16x16x32_bf16 v[44:47], v[140:143], v[160:163], v[44:47]
  ds_read_b64 v[76:77], v12 offset:1536
  v_mfma_f32_16x16x32_bf16 v[48:51], v[140:143], v[164:167], v[48:51]
  ds_read_b64 v[78:79], v12 offset:1544
  v_mfma_f32_16x16x32_bf16 v[52:55], v[140:143], v[168:171], v[52:55]
  ds_read_b64 v[108:109], v15 offset:2048
  v_mfma_f32_16x16x32_bf16 v[56:59], v[140:143], v[172:175], v[56:59]
  ds_read_b64 v[110:111], v15 offset:2056
  v_mfma_f32_16x16x32_bf16 v[48:51], v[128:131], v[176:179], v[48:51]
  ds_read_b64 v[80:81], v12 offset:2048
  v_mfma_f32_16x16x32_bf16 v[52:55], v[132:135], v[176:179], v[52:55]
  ds_read_b64 v[82:83], v12 offset:2056
  v_mfma_f32_16x16x32_bf16 v[56:59], v[136:139], v[176:179], v[56:59]
  ds_read_b64 v[112:113], v15 offset:1536
  v_mfma_f32_16x16x32_bf16 v[60:63], v[140:143], v[176:179], v[60:63]
  ds_read_b64 v[114:115], v15 offset:1544
  v_mfma_f32_16x16x32_bf16 v[48:51], v[144:147], v[160:163], v[48:51]
  ds_read_b64 v[84:85], v12 offset:2560
  v_mfma_f32_16x16x32_bf16 v[52:55], v[144:147], v[164:167], v[52:55]
  ds_read_b64 v[86:87], v12 offset:2568
  v_mfma_f32_16x16x32_bf16 v[56:59], v[144:147], v[168:171], v[56:59]
  ds_read_b64 v[116:117], v15 offset:1024
  v_mfma_f32_16x16x32_bf16 v[60:63], v[144:147], v[172:175], v[60:63]
  ds_read_b64 v[118:119], v15 offset:1032
  v_mfma_f32_16x16x32_bf16 v[52:55], v[128:131], v[180:183], v[52:55]
  ds_read_b64 v[88:89], v12 offset:3072
  v_mfma_f32_16x16x32_bf16 v[56:59], v[132:135], v[180:183], v[56:59]
  ds_read_b64 v[90:91], v12 offset:3080
  v_mfma_f32_16x16x32_bf16 v[60:63], v[136:139], v[180:183], v[60:63]
  ds_read_b64 v[120:121], v15 offset:512
  v_mfma_f32_16x16x32_bf16 v[52:55], v[148:151], v[160:163], v[52:55]
  ds_read_b64 v[122:123], v15 offset:520
  v_mfma_f32_16x16x32_bf16 v[56:59], v[148:151], v[164:167], v[56:59]
  ds_read_b64 v[92:93], v12 offset:3584
  v_mfma_f32_16x16x32_bf16 v[60:63], v[148:151], v[168:171], v[60:63]
  ds_read_b64 v[94:95], v12 offset:3592
  v_mfma_f32_16x16x32_bf16 v[56:59], v[128:131], v[184:187], v[56:59]
  ds_read_b64 v[124:125], v15 offset:0
  v_mfma_f32_16x16x32_bf16 v[60:63], v[132:135], v[184:187], v[60:63]
  ds_read_b64 v[126:127], v15 offset:8
  v_mfma_f32_16x16x32_bf16 v[56:59], v[152:155], v[160:163], v[56:59]
  v_mfma_f32_16x16x32_bf16 v[60:63], v[152:155], v[164:167], v[60:63]
  v_mfma_f32_16x16x32_bf16 v[60:63], v[128:131], v[188:191], v[60:63]
  v_mfma_f32_16x16x32_bf16 v[60:63], v[156:159], v[160:163], v[60:63]
  v_add_u32 v12, 64, v12
  v_add_u32 v13, 8, v13
  v_lshrrev_b32 v15, 3, v13
  v_and_b32 v15, 4, v15
  v_xor_b32 v15, v15, v13
  v_lshl_add_u32 v15, v15, 3, v14
  s_waitcnt lgkmcnt(0)
  v_mfma_f32_16x16x32_bf16 v[32:35], v[64:67], v[96:99], v[32:35]
  ds_read_b64 v[128:129], v12 offset:0
  v_mfma_f32_16x16x32_bf16 v[36:39], v[64:67], v[100:103], v[36:39]
  ds_read_b64 v[130:131], v12 offset:8
  v_mfma_f32_16x16x32_bf16 v[36:39], v[68:71], v[96:99], v[36:39]
  ds_read_b64 v[160:161], v15 offset:3584
  v_mfma_f32_16x16x32_bf16 v[40:43], v[68:71], v[100:103], v[40:43]
  ds_read_b64 v[162:163], v15 offset:3592
  v_mfma_f32_16x16x32_bf16 v[40:43], v[64:67], v[104:107], v[40:43]
  ds_read_b64 v[132:133], v12 offset:512
  v_mfma_f32_16x16x32_bf16 v[44:47], v[68:71], v[104:107], v[44:47]
  ds_read_b64 v[134:135], v12 offset:520
  v_mfma_f32_16x16x32_bf16 v[40:43], v[72:75], v[96:99], v[40:43]
  ds_read_b64 v[164:165], v15 offset:3072
  v_mfma_f32_16x16x32_bf16 v[44:47], v[72:75], v[100:103], v[44:47]
  ds_read_b64 v[166:167], v15 offset:3080
  v_mfma_f32_16x16x32_bf16 v[48:51], v[72:75], v[104:107], v[48:51]
  ds_read_b64 v[136:137], v12 offset:1024
  v_mfma_f32_16x16x32_bf16 v[44:47], v[64:67], v[108:111], v[44:47]
  ds_read_b64 v[138:139], v12 offset:1032
  v_mfma_f32_16x16x32_bf16 v[48:51], v[68:71], v[108:111], v[48:51]
  ds_read_b64 v[168:169], v15 offset:2560
  v_mfma_f32_16x16x32_bf16 v[52:55], v[72:75], v[108:111], v[52:55]
  ds_read_b64 v[170:171], v15 offset:2568
  v_mfma_f32_16x16x32_bf16 v[44:47], v[76:79], v[96:99], v[44:47]
  ds_read_b64 v[140:141], v12 offset:1536
  v_mfma_f32_16x16x32_bf16 v[48:51], v[76:79], v[100:103], v[48:51]
  ds_read_b64 v[142:143], v12 offset:1544
  v_mfma_f32_16x16x32_bf16 v[52:55], v[76:79], v[104:107], v[52:55]
  ds_read_b64 v[172:173], v15 offset:2048
  v_mfma_f32_16x16x32_bf16 v[56:59], v[76:79], v[108:111], v[56:59]
  ds_read_b64 v[174:175], v15 offset:2056
  v_mfma_f32_16x16x32_bf16 v[48:51], v[64:67], v[112:115], v[48:51]
  ds_read_b64 v[144:145], v12 offset:2048
  v_mfma_f32_16x16x32_bf16 v[52:55], v[68:71], v[112:115], v[52:55]
  ds_read_b64 v[146:147], v12 offset:2056
  v_mfma_f32_16x16x32_bf16 v[56:59], v[72:75], v[112:115], v[56:59]
  ds_read_b64 v[176:177], v15 offset:1536
  v_mfma_f32_16x16x32_bf16 v[60:63], v[76:79], v[112:115], v[60:63]
  ds_read_b64 v[178:179], v15 offset:1544
  v_mfma_f32_16x16x32_bf16 v[48:51], v[80:83], v[96:99], v[48:51]
  ds_read_b64 v[148:149], v12 offset:2560
  v_mfma_f32_16x16x32_bf16 v[52:55], v[80:83], v[100:103], v[52:55]
  ds_read_b64 v[150:151], v12 offset:2568
  v_mfma_f32_16x16x32_bf16 v[56:59], v[80:83], v[104:107], v[56:59]
  ds_read_b64 v[180:181], v15 offset:1024
  v_mfma_f32_16x16x32_bf16 v[60:63], v[80:83], v[108:111], v[60:63]
  ds_read_b64 v[182:183], v15 offset:1032
  v_mfma_f32_16x16x32_bf16 v[52:55], v[64:67], v[116:119], v[52:55]
  ds_read_b64 v[152:153], v12 offset:3072
  v_mfma_f32_16x16x32_bf16 v[56:59], v[68:71], v[116:119], v[56:59]
  ds_read_b64 v[154:155], v12 offset:3080
  v_mfma_f32_16x16x32_bf16 v[60:63], v[72:75], v[116:119], v[60:63]
  ds_read_b64 v[184:185], v15 offset:512
  v_mfma_f32_16x16x32_bf16 v[52:55], v[84:87], v[96:99], v[52:55]
  ds_read_b64 v[186:187], v15 offset:520
  v_mfma_f32_16x16x32_bf16 v[56:59], v[84:87], v[100:103], v[56:59]
  ds_read_b64 v[156:157], v12 offset:3584
  v_mfma_f32_16x16x32_bf16 v[60:63], v[84:87], v[104:107], v[60:63]
  ds_read_b64 v[158:159], v12 offset:3592
  v_mfma_f32_16x16x32_bf16 v[56:59], v[64:67], v[120:123], v[56:59]
  ds_read_b64 v[188:189], v15 offset:0
  v_mfma_f32_16x16x32_bf16 v[60:63], v[68:71], v[120:123], v[60:63]
  ds_read_b64 v[190:191], v15 offset:8
  v_mfma_f32_16x16x32_bf16 v[56:59], v[88:91], v[96:99], v[56:59]
  v_mfma_f32_16x16x32_bf16 v[60:63], v[88:91], v[100:103], v[60:63]
  v_mfma_f32_16x16x32_bf16 v[60:63], v[64:67], v[124:127], v[60:63]
  v_mfma_f32_16x16x32_bf16 v[60:63], v[92:95], v[96:99], v[60:63]
  s_waitcnt lgkmcnt(0)
  v_mfma_f32_16x16x32_bf16 v[32:35], v[128:131], v[160:163], v[32:35]
  v_mfma_f32_16x16x32_bf16 v[36:39], v[128:131], v[164:167], v[36:39]
  v_mfma_f32_16x16x32_bf16 v[36:39], v[132:135], v[160:163], v[36:39]
  v_mfma_f32_16x16x32_bf16 v[40:43], v[132:135], v[164:167], v[40:43]
  v_mfma_f32_16x16x32_bf16 v[40:43], v[128:131], v[168:171], v[40:43]
  v_mfma_f32_16x16x32_bf16 v[44:47], v[132:135], v[168:171], v[44:47]
  v_mfma_f32_16x16x32_bf16 v[40:43], v[136:139], v[160:163], v[40:43]
  v_mfma_f32_16x16x32_bf16 v[44:47], v[136:139], v[164:167], v[44:47]
  v_mfma_f32_16x16x32_bf16 v[48:51], v[136:139], v[168:171], v[48:51]
  v_mfma_f32_16x16x32_bf16 v[44:47], v[128:131], v[172:175], v[44:47]
  v_mfma_f32_16x16x32_bf16 v[48:51], v[132:135], v[172:175], v[48:51]
  v_mfma_f32_16x16x32_bf16 v[52:55], v[136:139], v[172:175], v[52:55]
  v_mfma_f32_16x16x32_bf16 v[44:47], v[140:143], v[160:163], v[44:47]
  v_mfma_f32_16x16x32_bf16 v[48:51], v[140:143], v[164:167], v[48:51]
  v_mfma_f32_16x16x32_bf16 v[52:55], v[140:143], v[168:171], v[52:55]
  v_mfma_f32_16x16x32_bf16 v[56:59], v[140:143], v[172:175], v[56:59]
  v_mfma_f32_16x16x32_bf16 v[48:51], v[128:131], v[176:179], v[48:51]
  v_mfma_f32_16x16x32_bf16 v[52:55], v[132:135], v[176:179], v[52:55]
  v_mfma_f32_16x16x32_bf16 v[56:59], v[136:139], v[176:179], v[56:59]
  v_mfma_f32_16x16x32_bf16 v[60:63], v[140:143], v[176:179], v[60:63]
  v_mfma_f32_16x16x32_bf16 v[48:51], v[144:147], v[160:163], v[48:51]
  v_mfma_f32_16x16x32_bf16 v[52:55], v[144:147], v[164:167], v[52:55]
  v_mfma_f32_16x16x32_bf16 v[56:59], v[144:147], v[168:171], v[56:59]
  v_mfma_f32_16x16x32_bf16 v[60:63], v[144:147], v[172:175], v[60:63]
  v_mfma_f32_16x16x32_bf16 v[52:55], v[128:131], v[180:183], v[52:55]
  v_mfma_f32_16x16x32_bf16 v[56:59], v[132:135], v[180:183], v[56:59]
  v_mfma_f32_16x16x32_bf16 v[60:63], v[136:139], v[180:183], v[60:63]
  v_mfma_f32_16x16x32_bf16 v[52:55], v[148:151], v[160:163], v[52:55]
  v_mfma_f32_16x16x32_bf16 v[56:59], v[148:151], v[164:167], v[56:59]
  v_mfma_f32_16x16x32_bf16 v[60:63], v[148:151], v[168:171], v[60:63]
  v_mfma_f32_16x16x32_bf16 v[56:59], v[128:131], v[184:187], v[56:59]
  v_mfma_f32_16x16x32_bf16 v[60:63], v[132:135], v[184:187], v[60:63]
  v_mfma_f32_16x16x32_bf16 v[56:59], v[152:155], v[160:163], v[56:59]
  v_mfma_f32_16x16x32_bf16 v[60:63], v[152:155], v[164:167], v[60:63]
  v_mfma_f32_16x16x32_bf16 v[60:63], v[128:131], v[188:191], v[60:63]
  v_mfma_f32_16x16x32_bf16 v[60:63], v[156:159], v[160:163], v[60:63]
  s_mul_i32 s53, s50, 9216
  s_add_u32 s53, s53, 36352
  v_mul_u32_u24 v9, 144, v11
  v_lshl_add_u32 v9, v30, 5, v9
  v_lshl_add_u32 v9, v10, 3, v9
  v_add_u32 v9, s53, v9
  v_lshrrev_b32 v12, 3, v0
  v_add_u32 v12, v12, v0
  v_lshlrev_b32 v12, 4, v12
  v_add_u32 v12, 36352, v12
  s_lshl_b32 s53, s64, 7
  s_lshl_b32 s54, s67, 12
  s_add_u32 s53, s53, s54
  s_add_u32 s53, s53, 1024
  v_lshrrev_b32 v13, 4, v0
  v_lshlrev_b32 v13, 17, v13
  v_bfe_u32 v14, v0, 3, 1
  v_lshl_add_u32 v13, v14, 11, v13
  v_and_b32 v14, 7, v0
  v_lshl_add_u32 v13, v14, 4, v13
  v_add_u32 v13, s53, v13
  v_add_u32 v14, 0x200000, v13
  s_waitcnt lgkmcnt(0)
  ds_write_b64 v9, v[32:33] offset:0
  ds_write_b64 v9, v[34:35] offset:16
  ds_write_b64 v9, v[36:37] offset:1152
  ds_write_b64 v9, v[38:39] offset:1168
  ds_write_b64 v9, v[40:41] offset:2304
  ds_write_b64 v9, v[42:43] offset:2320
  ds_write_b64 v9, v[44:45] offset:3456
  ds_write_b64 v9, v[46:47] offset:3472
  ds_write_b64 v9, v[48:49] offset:4608
  ds_write_b64 v9, v[50:51] offset:4624
  ds_write_b64 v9, v[52:53] offset:5760
  ds_write_b64 v9, v[54:55] offset:5776
  ds_write_b64 v9, v[56:57] offset:6912
  ds_write_b64 v9, v[58:59] offset:6928
  ds_write_b64 v9, v[60:61] offset:8064
  ds_write_b64 v9, v[62:63] offset:8080
  s_waitcnt lgkmcnt(0)
  s_barrier
  ds_read_b128 v[64:67], v12 offset:0
  ds_read_b128 v[68:71], v12 offset:9216
  ds_read_b128 v[72:75], v12 offset:18432
  ds_read_b128 v[76:79], v12 offset:27648
  ds_read_b128 v[80:83], v12 offset:4608
  ds_read_b128 v[84:87], v12 offset:13824
  ds_read_b128 v[88:91], v12 offset:23040
  ds_read_b128 v[92:95], v12 offset:32256
  s_waitcnt lgkmcnt(4)
  v_add_f32 v64, v64, v68
  v_add_f32 v65, v65, v69
  v_add_f32 v66, v66, v70
  v_add_f32 v67, v67, v71
  v_add_f32 v72, v72, v76
  v_add_f32 v73, v73, v77
  v_add_f32 v74, v74, v78
  v_add_f32 v75, v75, v79
  v_cvt_pk_bf16_f32 v68, v64, v72
  v_cvt_pk_bf16_f32 v69, v65, v73
  v_cvt_pk_bf16_f32 v70, v66, v74
  v_cvt_pk_bf16_f32 v71, v67, v75
  s_waitcnt lgkmcnt(0)
  v_add_f32 v80, v80, v84
  v_add_f32 v81, v81, v85
  v_add_f32 v82, v82, v86
  v_add_f32 v83, v83, v87
  v_add_f32 v88, v88, v92
  v_add_f32 v89, v89, v93
  v_add_f32 v90, v90, v94
  v_add_f32 v91, v91, v95
  v_cvt_pk_bf16_f32 v84, v80, v88
  v_cvt_pk_bf16_f32 v85, v81, v89
  v_cvt_pk_bf16_f32 v86, v82, v90
  v_cvt_pk_bf16_f32 v87, v83, v91
  s_cmp_lg_u32 s72, 0
  s_cbranch_scc1 LB_slow
  global_store_dwordx4 v13, v[68:71], s[36:37]
  global_store_dwordx4 v14, v[84:87], s[36:37]
  s_branch LB_pushed
LB_slow:
  global_store_dwordx4 v13, v[68:71], s[36:37] sc1
  global_store_dwordx4 v14, v[84:87], s[36:37] sc1
LB_pushed:
  v_lshrrev_b32 v11, 4, v0
  v_and_b32 v12, 15, v0
  v_lshrrev_b32 v15, 2, v11
  v_and_b32 v16, 7, v12
  v_xor_b32 v15, v15, v16
  v_lshlrev_b32 v15, 4, v15
  v_and_b32 v16, 3, v11
  v_lshl_add_u32 v15, v16, 2, v15
  v_lshl_add_u32 v15, v12, 9, v15
  v_xor_b32 v16, 64, v15
  v_lshrrev_b32 v11, 3, v0
  v_and_b32 v12, 7, v0
  v_bfe_u32 v17, v0, 5, 3
  v_xor_b32 v17, v17, v12
  v_lshlrev_b32 v17, 4, v17
  v_lshl_add_u32 v17, v11, 7, v17
  v_lshlrev_b32 v11, 11, v11
  v_lshl_add_u32 v11, v12, 4, v11
  v_add_u32 v11, s70, v11
  v_add_u32 v12, 0x10000, v11
  s_mov_b32 s66, 0
  s_mov_b64 s[60:61], -1
  s_mov_b64 s[62:63], -1
LB_opoll:
  s_mov_b64 exec, s[60:61]
  global_load_dwordx4 v[20:23], v11, s[36:37] sc1
  s_mov_b64 exec, s[62:63]
  global_load_dwordx4 v[24:27], v12, s[36:37] sc1
  s_mov_b64 exec, -1
  s_add_u32 s66, s66, 1
  s_cmp_gt_u32 s66, 0x4000
  s_waitcnt vmcnt(0)
  s_cbranch_scc1 LB_go
  v_max_u32 v28, v20, v21
  v_max_u32 v29, v24, v25
  v_max3_u32 v28, v22, v23, v28
  v_max3_u32 v29, v26, v27, v29
  v_cmp_eq_u32 s[60:61], -1, v28
  v_cmp_eq_u32 s[62:63], -1, v29
  s_nop 0
  s_or_b64 vcc, s[60:61], s[62:63]
  s_cbranch_scc0 LB_go
  s_sleep 2
  s_branch LB_opoll
LB_go:
  ds_write_b32 v15, v20 offset:0
  ds_write_b32 v15, v21 offset:128
  ds_write_b32 v15, v22 offset:256
  ds_write_b32 v15, v23 offset:384
  ds_write_b32 v16, v24 offset:0
  ds_write_b32 v16, v25 offset:128
  ds_write_b32 v16, v26 offset:256
  ds_write_b32 v16, v27 offset:384
  s_waitcnt lgkmcnt(0)
  s_barrier
  ds_read_b128 v[20:23], v17
  ds_read_b128 v[24:27], v17 offset:4096
  s_waitcnt lgkmcnt(1)
  global_store_dwordx4 v11, v[20:23], s[36:37]
  s_waitcnt lgkmcnt(0)
  global_store_dwordx4 v12, v[24:27], s[36:37]
  s_endpgm
L_code_end:
.section .rodata,"a"
.p2align 6
.amdhsa_kernel concat_heads__linear_attn_block__ssm_conv_s4d__prompt_kernel
  .amdhsa_next_free_vgpr 256
  .amdhsa_next_free_sgpr 102
  .amdhsa_accum_offset 256
  .amdhsa_group_segment_fixed_size 0
  .amdhsa_kernarg_size 104
  .amdhsa_user_sgpr_count 2
  .amdhsa_user_sgpr_kernarg_segment_ptr 1
  .amdhsa_system_sgpr_workgroup_id_x 1
  .amdhsa_ieee_mode 0
.end_amdhsa_kernel
```
